```python
import torch

def _softmax(x, axis=-1):
    return torch.softmax(x, dim=axis)
def _gelu(x):
    return torch.nn.functional.gelu(x, approximate="tanh")
def _silu(x):
    return torch.nn.functional.silu(x)
def _sigmoid(x):
    return torch.sigmoid(x)
def _layernorm(x, axis=-1, eps=1e-5):
    m = x.mean(dim=axis, keepdim=True)
    v = x.var(dim=axis, keepdim=True, unbiased=False)
    return (x - m) / torch.sqrt(v + eps)
def _scatter_add(tgt, idx, src, axis=0):
    return tgt.clone().index_add_(axis, idx, src)
def _segment_sum(src, seg, n):
    out = torch.zeros((n,) + src.shape[1:], dtype=src.dtype)
    return out.index_add_(0, seg, src)
def _pad(x, pw):
    flat = tuple(v for pair in reversed(pw) for v in pair)
    return torch.nn.functional.pad(x, flat)

kernel_name = 'sequential_preLN__ssm_conv_h3__mixer_channel_mlp__prompt'

def setup_inputs():

    _w = (lambda a: (lambda t: t.to(torch.bfloat16) if t.is_floating_point() else t)(torch.as_tensor(a)))
    def _A_setup():
        B, S, D = 1, 2048, 1024
        ks = 4
        return {
            "q": _w((lambda *s: torch.randn(*s, dtype=torch.bfloat16) * 0.05)(B, S, D)),
            "k": _w((lambda *s: torch.randn(*s, dtype=torch.bfloat16) * 0.2)(B, S, D)),
            "v": _w((lambda *s: torch.randn(*s, dtype=torch.bfloat16) * 0.2)(B, S, D)),
            "shift_k": _w((lambda *s: torch.randn(*s, dtype=torch.bfloat16) * 0.2)(D, ks) * 0.5),
            "ssm_k": _w((lambda *s: torch.randn(*s, dtype=torch.bfloat16) * 0.8)(D, S) * (1.0 / S ** 0.5)),
            "ssm_D": _w((lambda *s: torch.randn(*s, dtype=torch.bfloat16) * 0.2)(D)),
        }
    _A_in = _A_setup()

    def _B_setup():
        B, S, D, F = 1, 2048, 1024, 3584
        return {
            "x": _w((lambda *s: torch.randn(*s, dtype=torch.bfloat16) * 0.05)(B, S, D)),
            "w1": _w((lambda *s: torch.randn(*s, dtype=torch.bfloat16) * 0.8)(D, F) * (D ** -0.5)),
            "b1": _w((lambda *s: torch.randn(*s, dtype=torch.bfloat16) * 0.4)(F)),
            "w2": _w((lambda *s: torch.randn(*s, dtype=torch.bfloat16) * 0.05)(F, D) * (F ** -0.5)),
            "b2": _w((lambda *s: torch.randn(*s, dtype=torch.bfloat16) * 0.05)(D)),
        }
    _B_in = _B_setup()

    return {
        "A_q": _A_in["q"],
        "A_k": _A_in["k"],
        "A_v": _A_in["v"],
        "A_shift_k": _A_in["shift_k"],
        "A_ssm_k": _A_in["ssm_k"],
        "A_ssm_D": _A_in["ssm_D"],
        "B_x": _B_in["x"],
        "B_w1": _B_in["w1"],
        "B_b1": _B_in["b1"],
        "B_w2": _B_in["w2"],
        "B_b2": _B_in["b2"],
    }

def reference(A_q, A_k, A_v, A_shift_k, A_ssm_k, A_ssm_D, B_x, B_w1, B_b1, B_w2, B_b2):
    def _A_ref(q, k, v, shift_k, ssm_k, ssm_D):
        B, S, D = q.shape
        ks = shift_k.shape[-1]
        k_pad = _pad(k, ((0, 0), (ks - 1, 0), (0, 0)))
        k_shift = torch.zeros_like(k)
        for t in range(ks):
            k_shift = k_shift + k_pad[:, t:t + S, :] * shift_k[:, ks - 1 - t][None, None, :]
        kv = k_shift * v
        L = 2 * S
        kv_pad = _pad(kv, ((0, 0), (0, S), (0, 0)))
        kf_pad = _pad(ssm_k, ((0, 0), (0, S)))
        kv_f = (lambda x, axes=(-2,-1): torch.fft.rfft2(x.float(), dim=axes))(kv_pad[:, None, :, :], axes=(1, 2))
        kf_f = (lambda x, axes=(-2,-1): torch.fft.rfft2(x.float(), dim=axes))(kf_pad[:, None, :], axes=(1, 2))
        kf_f = (lambda x, *d: x.permute(*d))(kf_f, 1, 2, 0)
        y_f = kv_f * kf_f[None, :, :, :]
        y = (lambda x, s, axes=(-2,-1): torch.fft.irfft2(x, s=s, dim=axes).to(torch.bfloat16))(y_f, (1, L), axes=(1, 2))[:, 0, :S, :]
        y = y + kv * ssm_D[None, None, :]
        return q * y

    def _B_ref(x, w1, b1, w2, b2):
        y = _layernorm(x, axis=-1)
        h = _gelu(torch.einsum("bsd,df->bsf", y, w1) + b1)
        return torch.einsum("bsf,fd->bsd", h, w2) + b2

    x = A_q
    h = x + _A_ref(_layernorm(x, axis=-1), A_k, A_v, A_shift_k, A_ssm_k, A_ssm_D)
    h2 = h + _B_ref(_layernorm(h, axis=-1), B_w1, B_b1, B_w2, B_b2)
    return h2
```

```asm
; @launch grid=(256,1,1) block=(512,1,1) lds=163840
.amdgcn_target "amdgcn-amd-amdhsa--gfx950"
.text
.globl sequential_preLN__ssm_conv_h3__mixer_channel_mlp__prompt_kernel
.p2align 8
.type sequential_preLN__ssm_conv_h3__mixer_channel_mlp__prompt_kernel,@function
sequential_preLN__ssm_conv_h3__mixer_channel_mlp__prompt_kernel:
    s_cmp_ge_u32 s2, 256
    s_cbranch_scc1 L_end
    s_load_dwordx16 s[8:23], s[0:1], 0
    s_load_dwordx8 s[24:31], s[0:1], 64
    s_load_dwordx4 s[32:35], s[0:1], 96
    v_lshrrev_b32 v1, 6, v0
    s_nop 0
    v_readfirstlane_b32 s52, v1
    v_and_b32 v0, 63, v0
    s_and_b32 s53, s2, 7
    s_lshr_b32 s54, s2, 3
    v_mov_b32 v200, 0
    v_mov_b32 v201, 0
    v_mov_b32 v202, 0
    v_mov_b32 v203, 0
    v_mov_b32 v204, 0
    v_mov_b32 v205, 0
    v_mov_b32 v206, 0
    v_mov_b32 v207, 0
    v_mov_b32 v208, 0
    v_mov_b32 v209, 0
    v_mov_b32 v210, 0
    v_mov_b32 v2, 150528
    v_mov_b32 v3, 0
    v_lshl_add_u32 v2, v0, 2, v2
    ds_write_b32 v2, v3
    s_waitcnt lgkmcnt(0)
    s_barrier
    s_mov_b32 s36, s34
    s_mov_b32 s37, s35
    s_mov_b32 s38, 67108864
    s_mov_b32 s39, 0x20000
    s_load_dword s55, s[34:35], 32768
    s_and_b32 s58, s52, 3
    s_lshl_b32 s56, s53, 7
    s_lshl_b32 s57, s54, 2
    s_add_u32 s56, s56, s57
    s_add_u32 s63, s56, s58
    v_lshrrev_b32 v1, 3, v0
    v_and_b32 v2, 7, v0
    s_lshl_b32 s56, s53, 7
    s_lshl_b32 s57, s58, 5
    s_add_u32 s59, s56, s57
    v_lshl_add_u32 v3, v2, 2, s59
    s_lshl_b32 s56, s54, 6
    v_lshl_add_u32 v4, v1, 3, s56
    v_lshlrev_b32 v5, 11, v4
    v_lshl_add_u32 v5, v3, 1, v5
    s_cmp_ge_u32 s52, 4
    s_cbranch_scc1 L_p_b_1
    s_mov_b32 s40, s10
    s_mov_b32 s41, s11
    s_mov_b32 s42, 4194304
    s_mov_b32 s43, 0x20000
    s_mov_b32 s44, s12
    s_mov_b32 s45, s13
    s_mov_b32 s46, 4194304
    s_mov_b32 s47, 0x20000
    s_mov_b32 s48, s14
    s_mov_b32 s49, s15
    s_mov_b32 s50, 8192
    s_mov_b32 s51, 0x20000
    v_subrev_u32 v120, 6144, v5
    v_add_u32 v121, 4096, v120
    v_add_u32 v122, 8192, v120
    v_add_u32 v123, 12288, v120
    v_add_u32 v124, 16384, v120
    v_add_u32 v125, 20480, v120
    buffer_load_dwordx2 v[10:11], v120, s[40:43], 0 offen offset:0
    buffer_load_dwordx2 v[12:13], v120, s[40:43], 0 offen offset:2048
    buffer_load_dwordx2 v[14:15], v121, s[40:43], 0 offen offset:0
    buffer_load_dwordx2 v[16:17], v121, s[40:43], 0 offen offset:2048
    buffer_load_dwordx2 v[18:19], v122, s[40:43], 0 offen offset:0
    buffer_load_dwordx2 v[20:21], v122, s[40:43], 0 offen offset:2048
    buffer_load_dwordx2 v[22:23], v123, s[40:43], 0 offen offset:0
    buffer_load_dwordx2 v[24:25], v123, s[40:43], 0 offen offset:2048
    buffer_load_dwordx2 v[26:27], v124, s[40:43], 0 offen offset:0
    buffer_load_dwordx2 v[28:29], v124, s[40:43], 0 offen offset:2048
    buffer_load_dwordx2 v[30:31], v125, s[40:43], 0 offen offset:0
    v_lshlrev_b32 v7, 3, v3
    buffer_load_dwordx4 v[48:51], v7, s[48:51], 0 offen
    buffer_load_dwordx4 v[52:55], v7, s[48:51], 0 offen offset:16
    buffer_load_dwordx2 v[32:33], v121, s[44:47], 0 offen offset:2048
    buffer_load_dwordx2 v[34:35], v122, s[44:47], 0 offen offset:0
    buffer_load_dwordx2 v[36:37], v122, s[44:47], 0 offen offset:2048
    buffer_load_dwordx2 v[38:39], v123, s[44:47], 0 offen offset:0
    buffer_load_dwordx2 v[40:41], v123, s[44:47], 0 offen offset:2048
    buffer_load_dwordx2 v[42:43], v124, s[44:47], 0 offen offset:0
    buffer_load_dwordx2 v[44:45], v124, s[44:47], 0 offen offset:2048
    buffer_load_dwordx2 v[46:47], v125, s[44:47], 0 offen offset:0
    s_mov_b32 s40, s28
    s_mov_b32 s41, s29
    s_mov_b32 s42, 2048
    s_mov_b32 s43, 0x20000
    s_lshr_b32 s56, s53, 1
    s_lshl_b32 s56, s56, 2
    s_lshr_b32 s57, s54, 3
    s_add_u32 s56, s56, s57
    s_and_b32 s56, s56, 7
    s_lshr_b32 s57, s52, 1
    s_mov_b32 s56, s56
    s_lshl_b32 s56, s56, 8
    s_lshl_b32 s57, s57, 7
    s_add_u32 s56, s56, s57
    v_lshrrev_b32 v234, 4, v0
    v_lshl_add_u32 v242, v234, 3, s56
    buffer_load_dwordx2 v[234:235], v242, s[40:43], 0 offen offset:0
    buffer_load_dwordx2 v[236:237], v242, s[40:43], 0 offen offset:32
    buffer_load_dwordx2 v[238:239], v242, s[40:43], 0 offen offset:64
    buffer_load_dwordx2 v[240:241], v242, s[40:43], 0 offen offset:96
    s_getpc_b64 s[56:57]
L_pc:
    s_sub_u32 s56, s56, L_pc-sequential_preLN__ssm_conv_h3__mixer_channel_mlp__prompt_kernel
    s_subb_u32 s57, s57, 0
    s_lshl_b32 s60, s52, 13
    v_lshlrev_b32 v244, 7, v0
    v_add_u32 v244, s60, v244
    v_min_u32 v244, L_end-sequential_preLN__ssm_conv_h3__mixer_channel_mlp__prompt_kernel, v244
    global_load_dword v245, v244, s[56:57]
    v_mov_b32 v8, 0
    v_mov_b32 v9, 0
    s_mul_i32 s56, s58, 4608
    s_add_u32 s56, s56, 70656
    v_lshl_add_u32 v6, v0, 3, s56
    ds_write_b64 v6, v[8:9]
    s_lshl_b32 s56, s52, 12
    s_add_u32 s56, s56, 101376
    v_xor_b32 v126, v1, v2
    v_lshlrev_b32 v126, 4, v126
    v_lshl_add_u32 v126, v2, 9, v126
    v_add_u32 v126, s56, v126
    v_lshrrev_b32 v127, 5, v0
    v_lshl_add_u32 v128, v1, 7, s56
    v_add_u32 v129, 0, v127
    v_xor_b32 v129, v129, v2
    v_lshl_add_u32 v130, v129, 4, v128
    v_add_u32 v129, 2, v127
    v_xor_b32 v129, v129, v2
    v_lshl_add_u32 v131, v129, 4, v128
    v_add_u32 v129, 4, v127
    v_xor_b32 v129, v129, v2
    v_lshl_add_u32 v132, v129, 4, v128
    v_add_u32 v129, 6, v127
    v_xor_b32 v129, v129, v2
    v_lshl_add_u32 v133, v129, 4, v128
    v_lshlrev_b32 v6, 4, v2
    s_lshl_b32 s56, s54, 7
    s_sub_u32 s56, 4080, s56
    v_sub_u32 v6, s56, v6
    v_add_u32 v7, s59, v1
    v_lshl_add_u32 v6, v7, 12, v6
    v_add_u32 v6, 1048576, v6
    s_mov_b32 s65, 32768
    s_mov_b32 s66, 65536
    s_mov_b32 s67, 98304
    s_mov_b32 s64, 0
    s_waitcnt vmcnt(13)
    v_lshlrev_b32 v56, 16, v48
    v_lshlrev_b32 v57, 16, v50
    v_and_b32 v58, 0xffff0000, v48
    v_and_b32 v59, 0xffff0000, v50
    v_lshlrev_b32 v60, 16, v49
    v_lshlrev_b32 v61, 16, v51
    v_and_b32 v62, 0xffff0000, v49
    v_and_b32 v63, 0xffff0000, v51
    v_lshlrev_b32 v64, 16, v10
    v_and_b32 v65, 0xffff0000, v10
    v_lshlrev_b32 v66, 16, v12
    v_and_b32 v67, 0xffff0000, v12
    v_lshlrev_b32 v68, 16, v14
    v_and_b32 v69, 0xffff0000, v14
    v_lshlrev_b32 v70, 16, v16
    v_and_b32 v71, 0xffff0000, v16
    v_lshlrev_b32 v72, 16, v18
    v_and_b32 v73, 0xffff0000, v18
    v_lshlrev_b32 v74, 16, v20
    v_and_b32 v75, 0xffff0000, v20
    v_lshlrev_b32 v76, 16, v22
    v_and_b32 v77, 0xffff0000, v22
    v_lshlrev_b32 v78, 16, v24
    v_and_b32 v79, 0xffff0000, v24
    v_lshlrev_b32 v80, 16, v26
    v_and_b32 v81, 0xffff0000, v26
    v_lshlrev_b32 v82, 16, v28
    v_and_b32 v83, 0xffff0000, v28
    v_lshlrev_b32 v84, 16, v30
    v_and_b32 v85, 0xffff0000, v30
    s_waitcnt vmcnt(5)
    v_pk_mul_f32 v[86:87], v[70:71], v[56:57]
    v_pk_fma_f32 v[86:87], v[68:69], v[58:59], v[86:87]
    v_pk_fma_f32 v[86:87], v[66:67], v[60:61], v[86:87]
    v_pk_fma_f32 v[86:87], v[64:65], v[62:63], v[86:87]
    v_lshlrev_b32 v102, 16, v32
    v_and_b32 v103, 0xffff0000, v32
    v_pk_mul_f32 v[86:87], v[86:87], v[102:103]
    v_pk_mul_f32 v[88:89], v[72:73], v[56:57]
    v_pk_fma_f32 v[88:89], v[70:71], v[58:59], v[88:89]
    v_pk_fma_f32 v[88:89], v[68:69], v[60:61], v[88:89]
    v_pk_fma_f32 v[88:89], v[66:67], v[62:63], v[88:89]
    v_lshlrev_b32 v102, 16, v34
    v_and_b32 v103, 0xffff0000, v34
    v_pk_mul_f32 v[88:89], v[88:89], v[102:103]
    v_pk_mul_f32 v[90:91], v[74:75], v[56:57]
    v_pk_fma_f32 v[90:91], v[72:73], v[58:59], v[90:91]
    v_pk_fma_f32 v[90:91], v[70:71], v[60:61], v[90:91]
    v_pk_fma_f32 v[90:91], v[68:69], v[62:63], v[90:91]
    v_lshlrev_b32 v102, 16, v36
    v_and_b32 v103, 0xffff0000, v36
    v_pk_mul_f32 v[90:91], v[90:91], v[102:103]
    v_pk_mul_f32 v[92:93], v[76:77], v[56:57]
    v_pk_fma_f32 v[92:93], v[74:75], v[58:59], v[92:93]
    v_pk_fma_f32 v[92:93], v[72:73], v[60:61], v[92:93]
    v_pk_fma_f32 v[92:93], v[70:71], v[62:63], v[92:93]
    v_lshlrev_b32 v102, 16, v38
    v_and_b32 v103, 0xffff0000, v38
    v_pk_mul_f32 v[92:93], v[92:93], v[102:103]
    v_pk_mul_f32 v[94:95], v[78:79], v[56:57]
    v_pk_fma_f32 v[94:95], v[76:77], v[58:59], v[94:95]
    v_pk_fma_f32 v[94:95], v[74:75], v[60:61], v[94:95]
    v_pk_fma_f32 v[94:95], v[72:73], v[62:63], v[94:95]
    v_lshlrev_b32 v102, 16, v40
    v_and_b32 v103, 0xffff0000, v40
    v_pk_mul_f32 v[94:95], v[94:95], v[102:103]
    v_pk_mul_f32 v[96:97], v[80:81], v[56:57]
    v_pk_fma_f32 v[96:97], v[78:79], v[58:59], v[96:97]
    v_pk_fma_f32 v[96:97], v[76:77], v[60:61], v[96:97]
    v_pk_fma_f32 v[96:97], v[74:75], v[62:63], v[96:97]
    v_lshlrev_b32 v102, 16, v42
    v_and_b32 v103, 0xffff0000, v42
    v_pk_mul_f32 v[96:97], v[96:97], v[102:103]
    v_pk_mul_f32 v[98:99], v[82:83], v[56:57]
    v_pk_fma_f32 v[98:99], v[80:81], v[58:59], v[98:99]
    v_pk_fma_f32 v[98:99], v[78:79], v[60:61], v[98:99]
    v_pk_fma_f32 v[98:99], v[76:77], v[62:63], v[98:99]
    v_lshlrev_b32 v102, 16, v44
    v_and_b32 v103, 0xffff0000, v44
    v_pk_mul_f32 v[98:99], v[98:99], v[102:103]
    v_pk_mul_f32 v[100:101], v[84:85], v[56:57]
    v_pk_fma_f32 v[100:101], v[82:83], v[58:59], v[100:101]
    v_pk_fma_f32 v[100:101], v[80:81], v[60:61], v[100:101]
    v_pk_fma_f32 v[100:101], v[78:79], v[62:63], v[100:101]
    v_lshlrev_b32 v102, 16, v46
    v_and_b32 v103, 0xffff0000, v46
    v_pk_mul_f32 v[100:101], v[100:101], v[102:103]
    v_cvt_pk_bf16_f32 v104, v100, v98
    v_cvt_pk_bf16_f32 v105, v96, v94
    v_cvt_pk_bf16_f32 v106, v92, v90
    v_cvt_pk_bf16_f32 v107, v88, v86
    ds_write_b128 v126, v[104:107] offset:0
    v_cvt_pk_bf16_f32 v108, v101, v99
    v_cvt_pk_bf16_f32 v109, v97, v95
    v_cvt_pk_bf16_f32 v110, v93, v91
    v_cvt_pk_bf16_f32 v111, v89, v87
    ds_write_b128 v126, v[108:111] offset:128
    v_lshlrev_b32 v56, 16, v52
    v_lshlrev_b32 v57, 16, v54
    v_and_b32 v58, 0xffff0000, v52
    v_and_b32 v59, 0xffff0000, v54
    v_lshlrev_b32 v60, 16, v53
    v_lshlrev_b32 v61, 16, v55
    v_and_b32 v62, 0xffff0000, v53
    v_and_b32 v63, 0xffff0000, v55
    v_lshlrev_b32 v64, 16, v11
    v_and_b32 v65, 0xffff0000, v11
    v_lshlrev_b32 v66, 16, v13
    v_and_b32 v67, 0xffff0000, v13
    v_lshlrev_b32 v68, 16, v15
    v_and_b32 v69, 0xffff0000, v15
    v_lshlrev_b32 v70, 16, v17
    v_and_b32 v71, 0xffff0000, v17
    v_lshlrev_b32 v72, 16, v19
    v_and_b32 v73, 0xffff0000, v19
    v_lshlrev_b32 v74, 16, v21
    v_and_b32 v75, 0xffff0000, v21
    v_lshlrev_b32 v76, 16, v23
    v_and_b32 v77, 0xffff0000, v23
    v_lshlrev_b32 v78, 16, v25
    v_and_b32 v79, 0xffff0000, v25
    v_lshlrev_b32 v80, 16, v27
    v_and_b32 v81, 0xffff0000, v27
    v_lshlrev_b32 v82, 16, v29
    v_and_b32 v83, 0xffff0000, v29
    v_lshlrev_b32 v84, 16, v31
    v_and_b32 v85, 0xffff0000, v31
    v_pk_mul_f32 v[86:87], v[70:71], v[56:57]
    v_pk_fma_f32 v[86:87], v[68:69], v[58:59], v[86:87]
    v_pk_fma_f32 v[86:87], v[66:67], v[60:61], v[86:87]
    v_pk_fma_f32 v[86:87], v[64:65], v[62:63], v[86:87]
    v_lshlrev_b32 v102, 16, v33
    v_and_b32 v103, 0xffff0000, v33
    v_pk_mul_f32 v[86:87], v[86:87], v[102:103]
    v_pk_mul_f32 v[88:89], v[72:73], v[56:57]
    v_pk_fma_f32 v[88:89], v[70:71], v[58:59], v[88:89]
    v_pk_fma_f32 v[88:89], v[68:69], v[60:61], v[88:89]
    v_pk_fma_f32 v[88:89], v[66:67], v[62:63], v[88:89]
    v_lshlrev_b32 v102, 16, v35
    v_and_b32 v103, 0xffff0000, v35
    v_pk_mul_f32 v[88:89], v[88:89], v[102:103]
    v_pk_mul_f32 v[90:91], v[74:75], v[56:57]
    v_pk_fma_f32 v[90:91], v[72:73], v[58:59], v[90:91]
    v_pk_fma_f32 v[90:91], v[70:71], v[60:61], v[90:91]
    v_pk_fma_f32 v[90:91], v[68:69], v[62:63], v[90:91]
    v_lshlrev_b32 v102, 16, v37
    v_and_b32 v103, 0xffff0000, v37
    v_pk_mul_f32 v[90:91], v[90:91], v[102:103]
    v_pk_mul_f32 v[92:93], v[76:77], v[56:57]
    v_pk_fma_f32 v[92:93], v[74:75], v[58:59], v[92:93]
    v_pk_fma_f32 v[92:93], v[72:73], v[60:61], v[92:93]
    v_pk_fma_f32 v[92:93], v[70:71], v[62:63], v[92:93]
    v_lshlrev_b32 v102, 16, v39
    v_and_b32 v103, 0xffff0000, v39
    v_pk_mul_f32 v[92:93], v[92:93], v[102:103]
    v_pk_mul_f32 v[94:95], v[78:79], v[56:57]
    v_pk_fma_f32 v[94:95], v[76:77], v[58:59], v[94:95]
    v_pk_fma_f32 v[94:95], v[74:75], v[60:61], v[94:95]
    v_pk_fma_f32 v[94:95], v[72:73], v[62:63], v[94:95]
    v_lshlrev_b32 v102, 16, v41
    v_and_b32 v103, 0xffff0000, v41
    v_pk_mul_f32 v[94:95], v[94:95], v[102:103]
    v_pk_mul_f32 v[96:97], v[80:81], v[56:57]
    v_pk_fma_f32 v[96:97], v[78:79], v[58:59], v[96:97]
    v_pk_fma_f32 v[96:97], v[76:77], v[60:61], v[96:97]
    v_pk_fma_f32 v[96:97], v[74:75], v[62:63], v[96:97]
    v_lshlrev_b32 v102, 16, v43
    v_and_b32 v103, 0xffff0000, v43
    v_pk_mul_f32 v[96:97], v[96:97], v[102:103]
    v_pk_mul_f32 v[98:99], v[82:83], v[56:57]
    v_pk_fma_f32 v[98:99], v[80:81], v[58:59], v[98:99]
    v_pk_fma_f32 v[98:99], v[78:79], v[60:61], v[98:99]
    v_pk_fma_f32 v[98:99], v[76:77], v[62:63], v[98:99]
    v_lshlrev_b32 v102, 16, v45
    v_and_b32 v103, 0xffff0000, v45
    v_pk_mul_f32 v[98:99], v[98:99], v[102:103]
    v_pk_mul_f32 v[100:101], v[84:85], v[56:57]
    v_pk_fma_f32 v[100:101], v[82:83], v[58:59], v[100:101]
    v_pk_fma_f32 v[100:101], v[80:81], v[60:61], v[100:101]
    v_pk_fma_f32 v[100:101], v[78:79], v[62:63], v[100:101]
    v_lshlrev_b32 v102, 16, v47
    v_and_b32 v103, 0xffff0000, v47
    v_pk_mul_f32 v[100:101], v[100:101], v[102:103]
    v_cvt_pk_bf16_f32 v112, v100, v98
    v_cvt_pk_bf16_f32 v113, v96, v94
    v_cvt_pk_bf16_f32 v114, v92, v90
    v_cvt_pk_bf16_f32 v115, v88, v86
    ds_write_b128 v126, v[112:115] offset:256
    v_cvt_pk_bf16_f32 v116, v101, v99
    v_cvt_pk_bf16_f32 v117, v97, v95
    v_cvt_pk_bf16_f32 v118, v93, v91
    v_cvt_pk_bf16_f32 v119, v89, v87
    ds_write_b128 v126, v[116:119] offset:384
    s_waitcnt lgkmcnt(0)
    ds_read_b128 v[104:107], v130 offset:0
    ds_read_b128 v[108:111], v131 offset:1024
    ds_read_b128 v[112:115], v132 offset:2048
    ds_read_b128 v[116:119], v133 offset:3072
    s_waitcnt lgkmcnt(3)
    buffer_store_dwordx4 v[104:107], v6, s[36:39], s64 offen sc1
    s_waitcnt lgkmcnt(2)
    buffer_store_dwordx4 v[108:111], v6, s[36:39], s65 offen sc1
    s_waitcnt lgkmcnt(1)
    buffer_store_dwordx4 v[112:115], v6, s[36:39], s66 offen sc1
    s_waitcnt lgkmcnt(0)
    buffer_store_dwordx4 v[116:119], v6, s[36:39], s67 offen sc1
    s_and_b32 s56, s63, 0xfffffffe
    s_lshl_b32 s56, s56, 1
    s_load_dword s69, s[18:19], s56
    s_waitcnt lgkmcnt(0)
    s_and_b32 s55, s55, 0xfffffff0
    s_add_u32 s55, s55, 16
    s_waitcnt vmcnt(0)
    v_mov_b32 v250, 150528
    v_mov_b32 v251, 1
    s_mov_b64 exec, 1
    ds_add_rtn_u32 v252, v250, v251
    s_waitcnt lgkmcnt(0)
    v_readfirstlane_b32 s56, v252
    s_mov_b64 exec, -1
    s_cmp_eq_u32 s56, 3
    s_cbranch_scc0 L_cnt_3
    s_add_u32 s56, s55, 1
    v_mov_b32 v254, s56
    s_lshl_b32 s57, s53, 10
    s_lshr_b32 s56, s54, 2
    s_lshl_b32 s56, s56, 7
    s_add_u32 s57, s57, s56
    s_and_b32 s56, s54, 3
    s_lshl_b32 s56, s56, 2
    s_add_u32 s57, s57, s56
    v_mov_b32 v255, s57
    s_mov_b64 exec, 1
    buffer_store_dword v254, v255, s[36:39], 0 offen sc1
    s_mov_b64 exec, -1
L_cnt_3:
    s_branch L_p_e_2
L_p_b_1:
    s_mov_b32 s40, s8
    s_mov_b32 s41, s9
    s_mov_b32 s42, 4194304
    s_mov_b32 s43, 0x20000
    s_lshl_b32 s56, s2, 3
    s_lshl_b32 s57, s58, 1
    s_add_u32 s62, s56, s57
    s_lshl_b32 s56, s62, 11
    v_lshl_add_u32 v6, v0, 4, s56
    buffer_load_dwordx4 v[26:29], v6, s[40:43], 0 offen offset:0
    buffer_load_dwordx4 v[30:33], v6, s[40:43], 0 offen offset:1024
    buffer_load_dwordx4 v[34:37], v6, s[40:43], 0 offen offset:2048
    buffer_load_dwordx4 v[38:41], v6, s[40:43], 0 offen offset:3072
    s_lshl_b32 s56, s63, 12
    s_add_u32 s48, s16, s56
    s_addc_u32 s49, s17, 0
    s_mov_b32 s50, 4096
    s_mov_b32 s51, 0x20000
    v_lshlrev_b32 v8, 4, v0
    v_subrev_u32 v9, 32, v8
    buffer_load_dwordx4 v[140:143], v9, s[48:51], 0 offen
    buffer_load_dwordx2 v[144:145], v9, s[48:51], 0 offen offset:16
    v_add_u32 v9, 1024, v9
    buffer_load_dwordx4 v[146:149], v9, s[48:51], 0 offen
    buffer_load_dwordx2 v[150:151], v9, s[48:51], 0 offen offset:16
    v_add_u32 v9, 1024, v9
    buffer_load_dwordx4 v[152:155], v9, s[48:51], 0 offen
    buffer_load_dwordx2 v[156:157], v9, s[48:51], 0 offen offset:16
    v_add_u32 v9, 1024, v9
    buffer_load_dwordx4 v[158:161], v9, s[48:51], 0 offen
    buffer_load_dwordx2 v[162:163], v9, s[48:51], 0 offen offset:16
    v_add_u32 v9, 1024, v9
    buffer_load_dwordx4 v[164:167], v9, s[48:51], 0 offen
    buffer_load_dwordx2 v[168:169], v9, s[48:51], 0 offen offset:16
    v_mov_b32 v120, v5
    v_add_u32 v121, 4096, v5
    v_add_u32 v122, 8192, v5
    v_add_u32 v123, 12288, v5
    buffer_load_dwordx2 v[10:11], v120, s[40:43], 0 offen offset:0
    buffer_load_dwordx2 v[12:13], v120, s[40:43], 0 offen offset:2048
    buffer_load_dwordx2 v[14:15], v121, s[40:43], 0 offen offset:0
    buffer_load_dwordx2 v[16:17], v121, s[40:43], 0 offen offset:2048
    buffer_load_dwordx2 v[18:19], v122, s[40:43], 0 offen offset:0
    buffer_load_dwordx2 v[20:21], v122, s[40:43], 0 offen offset:2048
    buffer_load_dwordx2 v[22:23], v123, s[40:43], 0 offen offset:0
    buffer_load_dwordx2 v[24:25], v123, s[40:43], 0 offen offset:2048
    s_mov_b32 s44, s24
    s_mov_b32 s45, s25
    s_mov_b32 s46, 7168
    s_mov_b32 s47, 0x20000
    s_lshr_b32 s56, s53, 1
    s_lshl_b32 s56, s56, 2
    s_lshr_b32 s57, s54, 3
    s_add_u32 s56, s56, s57
    s_mul_i32 s56, s56, 448
    v_and_b32 v240, 15, v0
    v_min_u32 v240, 13, v240
    s_mul_i32 s57, s58, 14
    v_add_u32 v240, s57, v240
    v_lshl_add_u32 v240, v240, 3, s56
    buffer_load_dwordx2 v[240:241], v240, s[44:47], 0 offen
    s_and_b32 s56, s63, 0xfffffffe
    s_lshl_b32 s56, s56, 1
    s_load_dword s69, s[18:19], s56
    s_waitcnt vmcnt(19)
    v_lshlrev_b32 v44, 16, v26
    v_and_b32 v45, 0xffff0000, v26
    v_lshlrev_b32 v46, 16, v27
    v_and_b32 v47, 0xffff0000, v27
    v_lshlrev_b32 v48, 16, v28
    v_and_b32 v49, 0xffff0000, v28
    v_lshlrev_b32 v50, 16, v29
    v_and_b32 v51, 0xffff0000, v29
    v_lshlrev_b32 v52, 16, v30
    v_and_b32 v53, 0xffff0000, v30
    v_lshlrev_b32 v54, 16, v31
    v_and_b32 v55, 0xffff0000, v31
    v_lshlrev_b32 v56, 16, v32
    v_and_b32 v57, 0xffff0000, v32
    v_lshlrev_b32 v58, 16, v33
    v_and_b32 v59, 0xffff0000, v33
    v_lshlrev_b32 v60, 16, v34
    v_and_b32 v61, 0xffff0000, v34
    v_lshlrev_b32 v62, 16, v35
    v_and_b32 v63, 0xffff0000, v35
    v_lshlrev_b32 v64, 16, v36
    v_and_b32 v65, 0xffff0000, v36
    v_lshlrev_b32 v66, 16, v37
    v_and_b32 v67, 0xffff0000, v37
    v_lshlrev_b32 v68, 16, v38
    v_and_b32 v69, 0xffff0000, v38
    v_lshlrev_b32 v70, 16, v39
    v_and_b32 v71, 0xffff0000, v39
    v_lshlrev_b32 v72, 16, v40
    v_and_b32 v73, 0xffff0000, v40
    v_lshlrev_b32 v74, 16, v41
    v_and_b32 v75, 0xffff0000, v41
    v_pk_add_f32 v[84:85], v[44:45], v[46:47]
    v_pk_add_f32 v[84:85], v[84:85], v[48:49]
    v_pk_add_f32 v[84:85], v[84:85], v[50:51]
    v_pk_add_f32 v[84:85], v[84:85], v[52:53]
    v_pk_add_f32 v[84:85], v[84:85], v[54:55]
    v_pk_add_f32 v[84:85], v[84:85], v[56:57]
    v_pk_add_f32 v[84:85], v[84:85], v[58:59]
    v_add_f32 v80, v84, v85
    v_pk_add_f32 v[84:85], v[60:61], v[62:63]
    v_pk_add_f32 v[84:85], v[84:85], v[64:65]
    v_pk_add_f32 v[84:85], v[84:85], v[66:67]
    v_pk_add_f32 v[84:85], v[84:85], v[68:69]
    v_pk_add_f32 v[84:85], v[84:85], v[70:71]
    v_pk_add_f32 v[84:85], v[84:85], v[72:73]
    v_pk_add_f32 v[84:85], v[84:85], v[74:75]
    v_add_f32 v81, v84, v85
    v_add_f32_dpp v80, v80, v80 quad_perm:[1,0,3,2] row_mask:0xf bank_mask:0xf
    s_nop 0
    v_add_f32_dpp v81, v81, v81 quad_perm:[1,0,3,2] row_mask:0xf bank_mask:0xf
    v_add_f32_dpp v80, v80, v80 quad_perm:[2,3,0,1] row_mask:0xf bank_mask:0xf
    s_nop 0
    v_add_f32_dpp v81, v81, v81 quad_perm:[2,3,0,1] row_mask:0xf bank_mask:0xf
    v_add_f32_dpp v80, v80, v80 row_half_mirror row_mask:0xf bank_mask:0xf
    s_nop 0
    v_add_f32_dpp v81, v81, v81 row_half_mirror row_mask:0xf bank_mask:0xf
    v_add_f32_dpp v80, v80, v80 row_mirror row_mask:0xf bank_mask:0xf
    s_nop 0
    v_add_f32_dpp v81, v81, v81 row_mirror row_mask:0xf bank_mask:0xf
    v_mov_b32 v82, v80
    v_mov_b32 v83, v81
    s_nop 0
    v_permlane16_swap_b32 v82, v80
    v_permlane16_swap_b32 v83, v81
    v_add_f32 v80, v80, v82
    v_add_f32 v81, v81, v83
    v_mov_b32 v82, v80
    v_mov_b32 v83, v81
    s_nop 0
    v_permlane32_swap_b32 v82, v80
    v_permlane32_swap_b32 v83, v81
    v_add_f32 v80, v80, v82
    v_add_f32 v81, v81, v83
    v_mul_f32 v80, 0x3a800000, v80
    v_mul_f32 v81, 0x3a800000, v81
    v_sub_f32 v44, v44, v80
    v_sub_f32 v45, v45, v80
    v_sub_f32 v46, v46, v80
    v_sub_f32 v47, v47, v80
    v_sub_f32 v48, v48, v80
    v_sub_f32 v49, v49, v80
    v_sub_f32 v50, v50, v80
    v_sub_f32 v51, v51, v80
    v_sub_f32 v52, v52, v80
    v_sub_f32 v53, v53, v80
    v_sub_f32 v54, v54, v80
    v_sub_f32 v55, v55, v80
    v_sub_f32 v56, v56, v80
    v_sub_f32 v57, v57, v80
    v_sub_f32 v58, v58, v80
    v_sub_f32 v59, v59, v80
    v_pk_mul_f32 v[84:85], v[44:45], v[44:45]
    v_pk_fma_f32 v[84:85], v[46:47], v[46:47], v[84:85]
    v_pk_fma_f32 v[84:85], v[48:49], v[48:49], v[84:85]
    v_pk_fma_f32 v[84:85], v[50:51], v[50:51], v[84:85]
    v_pk_fma_f32 v[84:85], v[52:53], v[52:53], v[84:85]
    v_pk_fma_f32 v[84:85], v[54:55], v[54:55], v[84:85]
    v_pk_fma_f32 v[84:85], v[56:57], v[56:57], v[84:85]
    v_pk_fma_f32 v[84:85], v[58:59], v[58:59], v[84:85]
    v_add_f32 v86, v84, v85
    v_sub_f32 v60, v60, v81
    v_sub_f32 v61, v61, v81
    v_sub_f32 v62, v62, v81
    v_sub_f32 v63, v63, v81
    v_sub_f32 v64, v64, v81
    v_sub_f32 v65, v65, v81
    v_sub_f32 v66, v66, v81
    v_sub_f32 v67, v67, v81
    v_sub_f32 v68, v68, v81
    v_sub_f32 v69, v69, v81
    v_sub_f32 v70, v70, v81
    v_sub_f32 v71, v71, v81
    v_sub_f32 v72, v72, v81
    v_sub_f32 v73, v73, v81
    v_sub_f32 v74, v74, v81
    v_sub_f32 v75, v75, v81
    v_pk_mul_f32 v[84:85], v[60:61], v[60:61]
    v_pk_fma_f32 v[84:85], v[62:63], v[62:63], v[84:85]
    v_pk_fma_f32 v[84:85], v[64:65], v[64:65], v[84:85]
    v_pk_fma_f32 v[84:85], v[66:67], v[66:67], v[84:85]
    v_pk_fma_f32 v[84:85], v[68:69], v[68:69], v[84:85]
    v_pk_fma_f32 v[84:85], v[70:71], v[70:71], v[84:85]
    v_pk_fma_f32 v[84:85], v[72:73], v[72:73], v[84:85]
    v_pk_fma_f32 v[84:85], v[74:75], v[74:75], v[84:85]
    v_add_f32 v87, v84, v85
    v_add_f32_dpp v86, v86, v86 quad_perm:[1,0,3,2] row_mask:0xf bank_mask:0xf
    s_nop 0
    v_add_f32_dpp v87, v87, v87 quad_perm:[1,0,3,2] row_mask:0xf bank_mask:0xf
    v_add_f32_dpp v86, v86, v86 quad_perm:[2,3,0,1] row_mask:0xf bank_mask:0xf
    s_nop 0
    v_add_f32_dpp v87, v87, v87 quad_perm:[2,3,0,1] row_mask:0xf bank_mask:0xf
    v_add_f32_dpp v86, v86, v86 row_half_mirror row_mask:0xf bank_mask:0xf
    s_nop 0
    v_add_f32_dpp v87, v87, v87 row_half_mirror row_mask:0xf bank_mask:0xf
    v_add_f32_dpp v86, v86, v86 row_mirror row_mask:0xf bank_mask:0xf
    s_nop 0
    v_add_f32_dpp v87, v87, v87 row_mirror row_mask:0xf bank_mask:0xf
    v_mov_b32 v82, v86
    v_mov_b32 v83, v87
    s_nop 0
    v_permlane16_swap_b32 v82, v86
    v_permlane16_swap_b32 v83, v87
    v_add_f32 v86, v86, v82
    v_add_f32 v87, v87, v83
    v_mov_b32 v82, v86
    v_mov_b32 v83, v87
    s_nop 0
    v_permlane32_swap_b32 v82, v86
    v_permlane32_swap_b32 v83, v87
    v_add_f32 v86, v86, v82
    v_add_f32 v87, v87, v83
    v_mul_f32 v86, 0x3a800000, v86
    v_cvt_pk_bf16_f32 v86, v86, v86
    v_and_b32 v86, 0xffff0000, v86
    v_add_f32 v86, 0x3727c5ac, v86
    v_cvt_pk_bf16_f32 v86, v86, v86
    v_and_b32 v86, 0xffff0000, v86
    v_sqrt_f32 v86, v86
    s_nop 0
    v_cvt_pk_bf16_f32 v86, v86, v86
    v_and_b32 v86, 0xffff0000, v86
    v_rcp_f32 v89, v86
    v_cvt_pk_bf16_f32 v88, v80, v80
    v_and_b32 v88, 0xffff0000, v88
    v_mul_f32 v87, 0x3a800000, v87
    v_cvt_pk_bf16_f32 v87, v87, v87
    v_and_b32 v87, 0xffff0000, v87
    v_add_f32 v87, 0x3727c5ac, v87
    v_cvt_pk_bf16_f32 v87, v87, v87
    v_and_b32 v87, 0xffff0000, v87
    v_sqrt_f32 v87, v87
    s_nop 0
    v_cvt_pk_bf16_f32 v87, v87, v87
    v_and_b32 v87, 0xffff0000, v87
    v_rcp_f32 v91, v87
    v_cvt_pk_bf16_f32 v90, v81, v81
    v_and_b32 v90, 0xffff0000, v90
    s_lshl_b32 s56, s62, 3
    s_add_u32 s56, s56, 65536
    v_mov_b32 v6, s56
    s_mov_b64 exec, 1
    buffer_store_dwordx4 v[88:91], v6, s[36:39], 0 offen sc1
    s_mov_b64 exec, -1
    s_mul_i32 s56, s58, 16640
    v_add_u32 v8, s56, v8
    s_waitcnt vmcnt(18)
    ds_write_b128 v8, v[140:143] offset:0
    v_mov_b32 v172, v141
    v_mov_b32 v173, v142
    v_mov_b32 v174, v143
    v_mov_b32 v175, v144
    ds_write_b128 v8, v[172:175] offset:8320
    v_alignbit_b32 v176, v141, v140, 16
    v_alignbit_b32 v177, v142, v141, 16
    v_alignbit_b32 v178, v143, v142, 16
    v_alignbit_b32 v179, v144, v143, 16
    ds_write_b128 v8, v[176:179] offset:4160
    v_alignbit_b32 v180, v142, v141, 16
    v_alignbit_b32 v181, v143, v142, 16
    v_alignbit_b32 v182, v144, v143, 16
    v_alignbit_b32 v183, v145, v144, 16
    ds_write_b128 v8, v[180:183] offset:12480
    s_waitcnt vmcnt(16)
    ds_write_b128 v8, v[146:149] offset:1024
    v_mov_b32 v184, v147
    v_mov_b32 v185, v148
    v_mov_b32 v186, v149
    v_mov_b32 v187, v150
    ds_write_b128 v8, v[184:187] offset:9344
    v_alignbit_b32 v188, v147, v146, 16
    v_alignbit_b32 v189, v148, v147, 16
    v_alignbit_b32 v190, v149, v148, 16
    v_alignbit_b32 v191, v150, v149, 16
    ds_write_b128 v8, v[188:191] offset:5184
    v_alignbit_b32 v192, v148, v147, 16
    v_alignbit_b32 v193, v149, v148, 16
    v_alignbit_b32 v194, v150, v149, 16
    v_alignbit_b32 v195, v151, v150, 16
    ds_write_b128 v8, v[192:195] offset:13504
    s_waitcnt vmcnt(14)
    ds_write_b128 v8, v[152:155] offset:2048
    v_mov_b32 v172, v153
    v_mov_b32 v173, v154
    v_mov_b32 v174, v155
    v_mov_b32 v175, v156
    ds_write_b128 v8, v[172:175] offset:10368
    v_alignbit_b32 v176, v153, v152, 16
    v_alignbit_b32 v177, v154, v153, 16
    v_alignbit_b32 v178, v155, v154, 16
    v_alignbit_b32 v179, v156, v155, 16
    ds_write_b128 v8, v[176:179] offset:6208
    v_alignbit_b32 v180, v154, v153, 16
    v_alignbit_b32 v181, v155, v154, 16
    v_alignbit_b32 v182, v156, v155, 16
    v_alignbit_b32 v183, v157, v156, 16
    ds_write_b128 v8, v[180:183] offset:14528
    s_waitcnt vmcnt(12)
    ds_write_b128 v8, v[158:161] offset:3072
    v_mov_b32 v184, v159
    v_mov_b32 v185, v160
    v_mov_b32 v186, v161
    v_mov_b32 v187, v162
    ds_write_b128 v8, v[184:187] offset:11392
    v_alignbit_b32 v188, v159, v158, 16
    v_alignbit_b32 v189, v160, v159, 16
    v_alignbit_b32 v190, v161, v160, 16
    v_alignbit_b32 v191, v162, v161, 16
    ds_write_b128 v8, v[188:191] offset:7232
    v_alignbit_b32 v192, v160, v159, 16
    v_alignbit_b32 v193, v161, v160, 16
    v_alignbit_b32 v194, v162, v161, 16
    v_alignbit_b32 v195, v163, v162, 16
    ds_write_b128 v8, v[192:195] offset:15552
    s_waitcnt vmcnt(10)
    s_mov_b64 exec, 15
    ds_write_b128 v8, v[164:167] offset:4096
    v_mov_b32 v172, v165
    v_mov_b32 v173, v166
    v_mov_b32 v174, v167
    v_mov_b32 v175, v168
    ds_write_b128 v8, v[172:175] offset:12416
    v_alignbit_b32 v176, v165, v164, 16
    v_alignbit_b32 v177, v166, v165, 16
    v_alignbit_b32 v178, v167, v166, 16
    v_alignbit_b32 v179, v168, v167, 16
    ds_write_b128 v8, v[176:179] offset:8256
    v_alignbit_b32 v180, v166, v165, 16
    v_alignbit_b32 v181, v167, v166, 16
    v_alignbit_b32 v182, v168, v167, 16
    v_alignbit_b32 v183, v169, v168, 16
    ds_write_b128 v8, v[180:183] offset:16576
    s_mov_b64 exec, -1
    s_waitcnt lgkmcnt(0)
    v_mov_b32 v250, 150532
    v_mov_b32 v251, 1
    s_mov_b64 exec, 1
    ds_add_rtn_u32 v252, v250, v251
    s_waitcnt lgkmcnt(0)
    v_readfirstlane_b32 s56, v252
    s_mov_b64 exec, -1
    s_waitcnt lgkmcnt(0)
    s_and_b32 s55, s55, 0xfffffff0
    s_add_u32 s55, s55, 16
    s_waitcnt vmcnt(0)
    v_mov_b32 v250, 150536
    v_mov_b32 v251, 1
    s_mov_b64 exec, 1
    ds_add_rtn_u32 v252, v250, v251
    s_waitcnt lgkmcnt(0)
    v_readfirstlane_b32 s56, v252
    s_mov_b64 exec, -1
    s_cmp_eq_u32 s56, 3
    s_cbranch_scc0 L_cnt_5
    s_add_u32 s56, s55, 1
    v_mov_b32 v254, s56
    s_lshl_b32 s57, s53, 10
    s_lshr_b32 s56, s54, 2
    s_lshl_b32 s56, s56, 7
    s_add_u32 s57, s57, s56
    s_and_b32 s56, s54, 3
    s_lshl_b32 s56, s56, 2
    s_add_u32 s57, s57, s56
    s_add_u32 s57, s57, 8192
    v_mov_b32 v255, s57
    s_mov_b64 exec, 1
    buffer_store_dword v254, v255, s[36:39], 0 offen sc1
    s_mov_b64 exec, -1
L_cnt_5:
    s_lshl_b32 s56, s52, 12
    s_add_u32 s56, s56, 101376
    v_xor_b32 v126, v1, v2
    v_lshlrev_b32 v126, 4, v126
    v_lshl_add_u32 v126, v2, 9, v126
    v_add_u32 v126, s56, v126
    v_lshrrev_b32 v127, 5, v0
    v_lshl_add_u32 v128, v1, 7, s56
    v_add_u32 v129, 0, v127
    v_xor_b32 v129, v129, v2
    v_lshl_add_u32 v130, v129, 4, v128
    v_add_u32 v129, 2, v127
    v_xor_b32 v129, v129, v2
    v_lshl_add_u32 v131, v129, 4, v128
    v_add_u32 v129, 4, v127
    v_xor_b32 v129, v129, v2
    v_lshl_add_u32 v132, v129, 4, v128
    v_add_u32 v129, 6, v127
    v_xor_b32 v129, v129, v2
    v_lshl_add_u32 v133, v129, 4, v128
    v_lshlrev_b32 v6, 4, v2
    s_lshl_b32 s56, s54, 7
    v_add_u32 v6, s56, v6
    v_add_u32 v7, s59, v1
    v_lshl_add_u32 v6, v7, 12, v6
    v_add_u32 v7, 5242880, v6
    s_mov_b32 s65, 32768
    s_mov_b32 s66, 65536
    s_mov_b32 s67, 98304
    s_mov_b32 s64, 0
    s_mov_b32 s60, 0x05040100
    s_mov_b32 s61, 0x07060302
    v_perm_b32 v104, v12, v10, s60
    v_perm_b32 v105, v16, v14, s60
    v_perm_b32 v106, v20, v18, s60
    v_perm_b32 v107, v24, v22, s60
    ds_write_b128 v126, v[104:107] offset:0
    v_perm_b32 v108, v12, v10, s61
    v_perm_b32 v109, v16, v14, s61
    v_perm_b32 v110, v20, v18, s61
    v_perm_b32 v111, v24, v22, s61
    ds_write_b128 v126, v[108:111] offset:128
    v_perm_b32 v112, v13, v11, s60
    v_perm_b32 v113, v17, v15, s60
    v_perm_b32 v114, v21, v19, s60
    v_perm_b32 v115, v25, v23, s60
    ds_write_b128 v126, v[112:115] offset:256
    v_perm_b32 v116, v13, v11, s61
    v_perm_b32 v117, v17, v15, s61
    v_perm_b32 v118, v21, v19, s61
    v_perm_b32 v119, v25, v23, s61
    ds_write_b128 v126, v[116:119] offset:384
    ds_read_b128 v[104:107], v130 offset:0
    ds_read_b128 v[108:111], v131 offset:1024
    ds_read_b128 v[112:115], v132 offset:2048
    ds_read_b128 v[116:119], v133 offset:3072
    s_waitcnt lgkmcnt(0)
    v_mov_b32 v250, 150552
    s_mov_b32 s57, 0x400000
L_lw_6:
    ds_read_b32 v251, v250
    s_sub_u32 s57, s57, 1
    s_cmp_eq_u32 s57, 0
    s_cbranch_scc1 L_lwx_7
    s_waitcnt lgkmcnt(0)
    v_readfirstlane_b32 s56, v251
    s_nop 0
    s_cmp_lt_u32 s56, 4
    s_cbranch_scc1 L_lw_6
L_lwx_7:
    s_waitcnt lgkmcnt(0)
    buffer_store_dwordx4 v[104:107], v7, s[36:39], s64 offen sc1
    buffer_store_dwordx4 v[108:111], v7, s[36:39], s65 offen sc1
    buffer_store_dwordx4 v[112:115], v7, s[36:39], s66 offen sc1
    buffer_store_dwordx4 v[116:119], v7, s[36:39], s67 offen sc1
    s_waitcnt vmcnt(0)
    v_mov_b32 v250, 150556
    v_mov_b32 v251, 1
    s_mov_b64 exec, 1
    ds_add_rtn_u32 v252, v250, v251
    s_waitcnt lgkmcnt(0)
    v_readfirstlane_b32 s56, v252
    s_mov_b64 exec, -1
    s_cmp_eq_u32 s56, 3
    s_cbranch_scc0 L_cnt_8
    s_add_u32 s56, s55, 1
    v_mov_b32 v254, s56
    s_lshl_b32 s57, s53, 10
    s_lshr_b32 s56, s54, 2
    s_lshl_b32 s56, s56, 7
    s_add_u32 s57, s57, s56
    s_and_b32 s56, s54, 3
    s_lshl_b32 s56, s56, 2
    s_add_u32 s57, s57, s56
    s_add_u32 s57, s57, 16384
    v_mov_b32 v255, s57
    s_mov_b64 exec, 1
    buffer_store_dword v254, v255, s[36:39], 0 offen sc1
    s_mov_b64 exec, -1
L_cnt_8:
L_p_e_2:
    s_cmp_ge_u32 s52, 4
    s_cbranch_scc1 L_c_help_9
    s_and_b32 s58, s52, 3
    s_lshl_b32 s56, s53, 7
    s_lshl_b32 s57, s54, 2
    s_add_u32 s56, s56, s57
    s_add_u32 s63, s56, s58
    v_lshlrev_b32 v1, 4, v0
    s_cmp_eq_u32 s52, 0
    s_cbranch_scc0 L_c_p_12
    s_add_u32 s56, s55, 1
    v_and_b32 v252, 7, v0
    v_lshlrev_b32 v252, 7, v252
    s_lshl_b32 s57, s53, 10
    v_add_u32 v252, s57, v252
    s_mov_b32 s57, 0x200000
L_pollg_14:
    s_sleep 4
    s_mov_b64 exec, 0xff
    buffer_load_dwordx4 v[248:251], v252, s[36:39], 0 offen sc1
    s_sub_u32 s57, s57, 1
    s_cmp_eq_u32 s57, 0
    s_cbranch_scc1 L_pollgx_15
    s_waitcnt vmcnt(0)
    v_subrev_u32 v248, s56, v248
    v_subrev_u32 v249, s56, v249
    v_subrev_u32 v250, s56, v250
    v_subrev_u32 v251, s56, v251
    v_max_u32 v248, v248, v249
    v_max3_u32 v248, v248, v250, v251
    v_cmp_le_u32 vcc, 16, v248
    s_cbranch_vccnz L_pollg_14
L_pollgx_15:
    s_waitcnt vmcnt(0)
    s_mov_b64 exec, -1
    v_mov_b32 v250, 150544
    v_mov_b32 v251, 1
    s_mov_b64 exec, 1
    ds_add_rtn_u32 v252, v250, v251
    s_waitcnt lgkmcnt(0)
    v_readfirstlane_b32 s56, v252
    s_mov_b64 exec, -1
    s_branch L_c_p2_13
L_c_p_12:
    v_mov_b32 v250, 150544
    s_mov_b32 s57, 0x400000
L_lw_17:
    ds_read_b32 v251, v250
    s_sub_u32 s57, s57, 1
    s_cmp_eq_u32 s57, 0
    s_cbranch_scc1 L_lwx_18
    s_waitcnt lgkmcnt(0)
    v_readfirstlane_b32 s56, v251
    s_nop 0
    s_cmp_lt_u32 s56, 1
    s_cbranch_scc1 L_lw_17
L_lwx_18:
    s_waitcnt lgkmcnt(0)
L_c_p2_13:
    s_lshl_b32 s56, s63, 12
    s_add_u32 s60, s56, 1048576
    s_mul_i32 s56, s58, 4608
    s_add_u32 m0, s56, 66560
    s_nop 0
    buffer_load_dwordx4 v1, s[36:39], s60 offen sc1 lds
    s_add_u32 m0, m0, 1024
    s_add_u32 s60, s60, 1024
    buffer_load_dwordx4 v1, s[36:39], s60 offen sc1 lds
    s_add_u32 m0, m0, 1024
    s_add_u32 s60, s60, 1024
    buffer_load_dwordx4 v1, s[36:39], s60 offen sc1 lds
    s_add_u32 m0, m0, 1024
    s_add_u32 s60, s60, 1024
    buffer_load_dwordx4 v1, s[36:39], s60 offen sc1 lds
    v_mov_b32 v250, 150552
    v_mov_b32 v251, 1
    s_mov_b64 exec, 1
    ds_add_u32 v250, v251
    s_mov_b64 exec, -1
    v_and_b32 v2, 15, v0
    v_lshrrev_b32 v3, 4, v0
    v_add_u32 v6, 1, v2
    v_and_b32 v7, 3, v6
    v_mul_u32_u24 v7, 4160, v7
    v_and_b32 v6, 0x1c, v6
    v_lshl_add_u32 v7, v6, 1, v7
    v_lshl_add_u32 v7, v3, 4, v7
    s_mul_i32 s56, s58, 16640
    s_add_u32 s56, s56, 0
    v_add_u32 v8, s56, v7
    v_lshlrev_b32 v6, 5, v2
    v_lshlrev_b32 v7, 4, v3
    v_sub_u32 v6, v7, v6
    s_mul_i32 s56, s58, 4608
    s_add_u32 s56, s56, 67040
    v_add_u32 v9, s56, v6
    v_mov_b32 v250, 150532
    s_mov_b32 s57, 0x400000
L_lw_19:
    ds_read_b32 v251, v250
    s_sub_u32 s57, s57, 1
    s_cmp_eq_u32 s57, 0
    s_cbranch_scc1 L_lwx_20
    s_waitcnt lgkmcnt(0)
    v_readfirstlane_b32 s56, v251
    s_nop 0
    s_cmp_lt_u32 s56, 4
    s_cbranch_scc1 L_lw_19
L_lwx_20:
    s_waitcnt lgkmcnt(0)
    s_waitcnt vmcnt(0)
    ds_read_b128 v[74:77], v9 offset:3584
    ds_read_b64 v[42:43], v8 offset:0
    ds_read_b64 v[44:45], v8 offset:8
    ds_read_b128 v[78:81], v9 offset:3072
    ds_read_b64 v[46:47], v8 offset:512
    ds_read_b64 v[48:49], v8 offset:520
    ds_read_b128 v[82:85], v9 offset:2560
    ds_read_b64 v[50:51], v8 offset:1024
    ds_read_b64 v[52:53], v8 offset:1032
    ds_read_b128 v[86:89], v9 offset:2048
    ds_read_b64 v[54:55], v8 offset:1536
    ds_read_b64 v[56:57], v8 offset:1544
    ds_read_b128 v[90:93], v9 offset:1536
    ds_read_b64 v[58:59], v8 offset:2048
    ds_read_b64 v[60:61], v8 offset:2056
    ds_read_b128 v[94:97], v9 offset:1024
    ds_read_b64 v[62:63], v8 offset:2560
    ds_read_b64 v[64:65], v8 offset:2568
    ds_read_b128 v[98:101], v9 offset:512
    ds_read_b64 v[66:67], v8 offset:3072
    ds_read_b64 v[68:69], v8 offset:3080
    ds_read_b128 v[102:105], v9 offset:0
    ds_read_b64 v[70:71], v8 offset:3584
    ds_read_b64 v[72:73], v8 offset:3592
    s_waitcnt lgkmcnt(0)
    v_mfma_f32_16x16x32_bf16 v[10:13], v[42:45], v[74:77], 0
    ds_read_b128 v[138:141], v9 offset:3648
    v_mfma_f32_16x16x32_bf16 v[14:17], v[42:45], v[78:81], 0
    ds_read_b64 v[106:107], v8 offset:64
    v_mfma_f32_16x16x32_bf16 v[14:17], v[46:49], v[74:77], v[14:17]
    ds_read_b64 v[108:109], v8 offset:72
    v_mfma_f32_16x16x32_bf16 v[18:21], v[46:49], v[78:81], 0
    ds_read_b128 v[142:145], v9 offset:3136
    v_mfma_f32_16x16x32_bf16 v[18:21], v[42:45], v[82:85], v[18:21]
    ds_read_b64 v[110:111], v8 offset:576
    v_mfma_f32_16x16x32_bf16 v[18:21], v[50:53], v[74:77], v[18:21]
    ds_read_b64 v[112:113], v8 offset:584
    v_mfma_f32_16x16x32_bf16 v[22:25], v[46:49], v[82:85], 0
    ds_read_b128 v[146:149], v9 offset:2624
    v_mfma_f32_16x16x32_bf16 v[22:25], v[50:53], v[78:81], v[22:25]
    ds_read_b64 v[114:115], v8 offset:1088
    v_mfma_f32_16x16x32_bf16 v[26:29], v[50:53], v[82:85], 0
    ds_read_b64 v[116:117], v8 offset:1096
    v_mfma_f32_16x16x32_bf16 v[22:25], v[42:45], v[86:89], v[22:25]
    ds_read_b128 v[150:153], v9 offset:2112
    v_mfma_f32_16x16x32_bf16 v[22:25], v[54:57], v[74:77], v[22:25]
    ds_read_b64 v[118:119], v8 offset:1600
    v_mfma_f32_16x16x32_bf16 v[26:29], v[46:49], v[86:89], v[26:29]
    ds_read_b64 v[120:121], v8 offset:1608
    v_mfma_f32_16x16x32_bf16 v[26:29], v[54:57], v[78:81], v[26:29]
    ds_read_b128 v[154:157], v9 offset:1600
    v_mfma_f32_16x16x32_bf16 v[30:33], v[50:53], v[86:89], 0
    ds_read_b64 v[122:123], v8 offset:2112
    v_mfma_f32_16x16x32_bf16 v[30:33], v[54:57], v[82:85], v[30:33]
    ds_read_b64 v[124:125], v8 offset:2120
    v_mfma_f32_16x16x32_bf16 v[34:37], v[54:57], v[86:89], 0
    ds_read_b128 v[158:161], v9 offset:1088
    v_mfma_f32_16x16x32_bf16 v[26:29], v[42:45], v[90:93], v[26:29]
    ds_read_b64 v[126:127], v8 offset:2624
    v_mfma_f32_16x16x32_bf16 v[26:29], v[58:61], v[74:77], v[26:29]
    ds_read_b64 v[128:129], v8 offset:2632
    v_mfma_f32_16x16x32_bf16 v[30:33], v[46:49], v[90:93], v[30:33]
    ds_read_b128 v[162:165], v9 offset:576
    v_mfma_f32_16x16x32_bf16 v[30:33], v[58:61], v[78:81], v[30:33]
    ds_read_b64 v[130:131], v8 offset:3136
    v_mfma_f32_16x16x32_bf16 v[34:37], v[50:53], v[90:93], v[34:37]
    ds_read_b64 v[132:133], v8 offset:3144
    v_mfma_f32_16x16x32_bf16 v[34:37], v[58:61], v[82:85], v[34:37]
    ds_read_b128 v[166:169], v9 offset:64
    v_mfma_f32_16x16x32_bf16 v[38:41], v[54:57], v[90:93], 0
    ds_read_b64 v[134:135], v8 offset:3648
    v_mfma_f32_16x16x32_bf16 v[38:41], v[58:61], v[86:89], v[38:41]
    ds_read_b64 v[136:137], v8 offset:3656
    v_mfma_f32_16x16x32_bf16 v[30:33], v[42:45], v[94:97], v[30:33]
    v_mfma_f32_16x16x32_bf16 v[30:33], v[62:65], v[74:77], v[30:33]
    v_mfma_f32_16x16x32_bf16 v[34:37], v[46:49], v[94:97], v[34:37]
    v_mfma_f32_16x16x32_bf16 v[34:37], v[62:65], v[78:81], v[34:37]
    v_mfma_f32_16x16x32_bf16 v[38:41], v[50:53], v[94:97], v[38:41]
    v_mfma_f32_16x16x32_bf16 v[38:41], v[62:65], v[82:85], v[38:41]
    v_mfma_f32_16x16x32_bf16 v[34:37], v[42:45], v[98:101], v[34:37]
    v_mfma_f32_16x16x32_bf16 v[34:37], v[66:69], v[74:77], v[34:37]
    v_mfma_f32_16x16x32_bf16 v[38:41], v[46:49], v[98:101], v[38:41]
    v_mfma_f32_16x16x32_bf16 v[38:41], v[66:69], v[78:81], v[38:41]
    v_mfma_f32_16x16x32_bf16 v[38:41], v[42:45], v[102:105], v[38:41]
    v_mfma_f32_16x16x32_bf16 v[38:41], v[70:73], v[74:77], v[38:41]
    s_waitcnt lgkmcnt(0)
    v_mfma_f32_16x16x32_bf16 v[10:13], v[106:109], v[138:141], v[10:13]
    ds_read_b128 v[74:77], v9 offset:3712
    v_mfma_f32_16x16x32_bf16 v[14:17], v[106:109], v[142:145], v[14:17]
    ds_read_b64 v[42:43], v8 offset:128
    v_mfma_f32_16x16x32_bf16 v[14:17], v[110:113], v[138:141], v[14:17]
    ds_read_b64 v[44:45], v8 offset:136
    v_mfma_f32_16x16x32_bf16 v[18:21], v[110:113], v[142:145], v[18:21]
    ds_read_b128 v[78:81], v9 offset:3200
    v_mfma_f32_16x16x32_bf16 v[18:21], v[106:109], v[146:149], v[18:21]
    ds_read_b64 v[46:47], v8 offset:640
    v_mfma_f32_16x16x32_bf16 v[18:21], v[114:117], v[138:141], v[18:21]
    ds_read_b64 v[48:49], v8 offset:648
    v_mfma_f32_16x16x32_bf16 v[22:25], v[110:113], v[146:149], v[22:25]
    ds_read_b128 v[82:85], v9 offset:2688
    v_mfma_f32_16x16x32_bf16 v[22:25], v[114:117], v[142:145], v[22:25]
    ds_read_b64 v[50:51], v8 offset:1152
    v_mfma_f32_16x16x32_bf16 v[26:29], v[114:117], v[146:149], v[26:29]
    ds_read_b64 v[52:53], v8 offset:1160
    v_mfma_f32_16x16x32_bf16 v[22:25], v[106:109], v[150:153], v[22:25]
    ds_read_b128 v[86:89], v9 offset:2176
    v_mfma_f32_16x16x32_bf16 v[22:25], v[118:121], v[138:141], v[22:25]
    ds_read_b64 v[54:55], v8 offset:1664
    v_mfma_f32_16x16x32_bf16 v[26:29], v[110:113], v[150:153], v[26:29]
    ds_read_b64 v[56:57], v8 offset:1672
    v_mfma_f32_16x16x32_bf16 v[26:29], v[118:121], v[142:145], v[26:29]
    ds_read_b128 v[90:93], v9 offset:1664
    v_mfma_f32_16x16x32_bf16 v[30:33], v[114:117], v[150:153], v[30:33]
    ds_read_b64 v[58:59], v8 offset:2176
    v_mfma_f32_16x16x32_bf16 v[30:33], v[118:121], v[146:149], v[30:33]
    ds_read_b64 v[60:61], v8 offset:2184
    v_mfma_f32_16x16x32_bf16 v[34:37], v[118:121], v[150:153], v[34:37]
    ds_read_b128 v[94:97], v9 offset:1152
    v_mfma_f32_16x16x32_bf16 v[26:29], v[106:109], v[154:157], v[26:29]
    ds_read_b64 v[62:63], v8 offset:2688
    v_mfma_f32_16x16x32_bf16 v[26:29], v[122:125], v[138:141], v[26:29]
    ds_read_b64 v[64:65], v8 offset:2696
    v_mfma_f32_16x16x32_bf16 v[30:33], v[110:113], v[154:157], v[30:33]
    ds_read_b128 v[98:101], v9 offset:640
    v_mfma_f32_16x16x32_bf16 v[30:33], v[122:125], v[142:145], v[30:33]
    ds_read_b64 v[66:67], v8 offset:3200
    v_mfma_f32_16x16x32_bf16 v[34:37], v[114:117], v[154:157], v[34:37]
    ds_read_b64 v[68:69], v8 offset:3208
    v_mfma_f32_16x16x32_bf16 v[34:37], v[122:125], v[146:149], v[34:37]
    ds_read_b128 v[102:105], v9 offset:128
    v_mfma_f32_16x16x32_bf16 v[38:41], v[118:121], v[154:157], v[38:41]
    ds_read_b64 v[70:71], v8 offset:3712
    v_mfma_f32_16x16x32_bf16 v[38:41], v[122:125], v[150:153], v[38:41]
    ds_read_b64 v[72:73], v8 offset:3720
    v_mfma_f32_16x16x32_bf16 v[30:33], v[106:109], v[158:161], v[30:33]
    v_mfma_f32_16x16x32_bf16 v[30:33], v[126:129], v[138:141], v[30:33]
    v_mfma_f32_16x16x32_bf16 v[34:37], v[110:113], v[158:161], v[34:37]
    v_mfma_f32_16x16x32_bf16 v[34:37], v[126:129], v[142:145], v[34:37]
    v_mfma_f32_16x16x32_bf16 v[38:41], v[114:117], v[158:161], v[38:41]
    v_mfma_f32_16x16x32_bf16 v[38:41], v[126:129], v[146:149], v[38:41]
    v_mfma_f32_16x16x32_bf16 v[34:37], v[106:109], v[162:165], v[34:37]
    v_mfma_f32_16x16x32_bf16 v[34:37], v[130:133], v[138:141], v[34:37]
    v_mfma_f32_16x16x32_bf16 v[38:41], v[110:113], v[162:165], v[38:41]
    v_mfma_f32_16x16x32_bf16 v[38:41], v[130:133], v[142:145], v[38:41]
    v_mfma_f32_16x16x32_bf16 v[38:41], v[106:109], v[166:169], v[38:41]
    v_mfma_f32_16x16x32_bf16 v[38:41], v[134:137], v[138:141], v[38:41]
    s_waitcnt lgkmcnt(0)
    v_mfma_f32_16x16x32_bf16 v[10:13], v[42:45], v[74:77], v[10:13]
    ds_read_b128 v[138:141], v9 offset:3776
    v_mfma_f32_16x16x32_bf16 v[14:17], v[42:45], v[78:81], v[14:17]
    ds_read_b64 v[106:107], v8 offset:192
    v_mfma_f32_16x16x32_bf16 v[14:17], v[46:49], v[74:77], v[14:17]
    ds_read_b64 v[108:109], v8 offset:200
    v_mfma_f32_16x16x32_bf16 v[18:21], v[46:49], v[78:81], v[18:21]
    ds_read_b128 v[142:145], v9 offset:3264
    v_mfma_f32_16x16x32_bf16 v[18:21], v[42:45], v[82:85], v[18:21]
    ds_read_b64 v[110:111], v8 offset:704
    v_mfma_f32_16x16x32_bf16 v[18:21], v[50:53], v[74:77], v[18:21]
    ds_read_b64 v[112:113], v8 offset:712
    v_mfma_f32_16x16x32_bf16 v[22:25], v[46:49], v[82:85], v[22:25]
    ds_read_b128 v[146:149], v9 offset:2752
    v_mfma_f32_16x16x32_bf16 v[22:25], v[50:53], v[78:81], v[22:25]
    ds_read_b64 v[114:115], v8 offset:1216
    v_mfma_f32_16x16x32_bf16 v[26:29], v[50:53], v[82:85], v[26:29]
    ds_read_b64 v[116:117], v8 offset:1224
    v_mfma_f32_16x16x32_bf16 v[22:25], v[42:45], v[86:89], v[22:25]
    ds_read_b128 v[150:153], v9 offset:2240
    v_mfma_f32_16x16x32_bf16 v[22:25], v[54:57], v[74:77], v[22:25]
    ds_read_b64 v[118:119], v8 offset:1728
    v_mfma_f32_16x16x32_bf16 v[26:29], v[46:49], v[86:89], v[26:29]
    ds_read_b64 v[120:121], v8 offset:1736
    v_mfma_f32_16x16x32_bf16 v[26:29], v[54:57], v[78:81], v[26:29]
    ds_read_b128 v[154:157], v9 offset:1728
    v_mfma_f32_16x16x32_bf16 v[30:33], v[50:53], v[86:89], v[30:33]
    ds_read_b64 v[122:123], v8 offset:2240
    v_mfma_f32_16x16x32_bf16 v[30:33], v[54:57], v[82:85], v[30:33]
    ds_read_b64 v[124:125], v8 offset:2248
    v_mfma_f32_16x16x32_bf16 v[34:37], v[54:57], v[86:89], v[34:37]
    ds_read_b128 v[158:161], v9 offset:1216
    v_mfma_f32_16x16x32_bf16 v[26:29], v[42:45], v[90:93], v[26:29]
    ds_read_b64 v[126:127], v8 offset:2752
    v_mfma_f32_16x16x32_bf16 v[26:29], v[58:61], v[74:77], v[26:29]
    ds_read_b64 v[128:129], v8 offset:2760
    v_mfma_f32_16x16x32_bf16 v[30:33], v[46:49], v[90:93], v[30:33]
    ds_read_b128 v[162:165], v9 offset:704
    v_mfma_f32_16x16x32_bf16 v[30:33], v[58:61], v[78:81], v[30:33]
    ds_read_b64 v[130:131], v8 offset:3264
    v_mfma_f32_16x16x32_bf16 v[34:37], v[50:53], v[90:93], v[34:37]
    ds_read_b64 v[132:133], v8 offset:3272
    v_mfma_f32_16x16x32_bf16 v[34:37], v[58:61], v[82:85], v[34:37]
    ds_read_b128 v[166:169], v9 offset:192
    v_mfma_f32_16x16x32_bf16 v[38:41], v[54:57], v[90:93], v[38:41]
    ds_read_b64 v[134:135], v8 offset:3776
    v_mfma_f32_16x16x32_bf16 v[38:41], v[58:61], v[86:89], v[38:41]
    ds_read_b64 v[136:137], v8 offset:3784
    v_mfma_f32_16x16x32_bf16 v[30:33], v[42:45], v[94:97], v[30:33]
    v_mfma_f32_16x16x32_bf16 v[30:33], v[62:65], v[74:77], v[30:33]
    v_mfma_f32_16x16x32_bf16 v[34:37], v[46:49], v[94:97], v[34:37]
    v_mfma_f32_16x16x32_bf16 v[34:37], v[62:65], v[78:81], v[34:37]
    v_mfma_f32_16x16x32_bf16 v[38:41], v[50:53], v[94:97], v[38:41]
    v_mfma_f32_16x16x32_bf16 v[38:41], v[62:65], v[82:85], v[38:41]
    v_mfma_f32_16x16x32_bf16 v[34:37], v[42:45], v[98:101], v[34:37]
    v_mfma_f32_16x16x32_bf16 v[34:37], v[66:69], v[74:77], v[34:37]
    v_mfma_f32_16x16x32_bf16 v[38:41], v[46:49], v[98:101], v[38:41]
    v_mfma_f32_16x16x32_bf16 v[38:41], v[66:69], v[78:81], v[38:41]
    v_mfma_f32_16x16x32_bf16 v[38:41], v[42:45], v[102:105], v[38:41]
    v_mfma_f32_16x16x32_bf16 v[38:41], v[70:73], v[74:77], v[38:41]
    s_waitcnt lgkmcnt(0)
    v_mfma_f32_16x16x32_bf16 v[10:13], v[106:109], v[138:141], v[10:13]
    ds_read_b128 v[74:77], v9 offset:3840
    v_mfma_f32_16x16x32_bf16 v[14:17], v[106:109], v[142:145], v[14:17]
    ds_read_b64 v[42:43], v8 offset:256
    v_mfma_f32_16x16x32_bf16 v[14:17], v[110:113], v[138:141], v[14:17]
    ds_read_b64 v[44:45], v8 offset:264
    v_mfma_f32_16x16x32_bf16 v[18:21], v[110:113], v[142:145], v[18:21]
    ds_read_b128 v[78:81], v9 offset:3328
    v_mfma_f32_16x16x32_bf16 v[18:21], v[106:109], v[146:149], v[18:21]
    ds_read_b64 v[46:47], v8 offset:768
    v_mfma_f32_16x16x32_bf16 v[18:21], v[114:117], v[138:141], v[18:21]
    ds_read_b64 v[48:49], v8 offset:776
    v_mfma_f32_16x16x32_bf16 v[22:25], v[110:113], v[146:149], v[22:25]
    ds_read_b128 v[82:85], v9 offset:2816
    v_mfma_f32_16x16x32_bf16 v[22:25], v[114:117], v[142:145], v[22:25]
    ds_read_b64 v[50:51], v8 offset:1280
    v_mfma_f32_16x16x32_bf16 v[26:29], v[114:117], v[146:149], v[26:29]
    ds_read_b64 v[52:53], v8 offset:1288
    v_mfma_f32_16x16x32_bf16 v[22:25], v[106:109], v[150:153], v[22:25]
    ds_read_b128 v[86:89], v9 offset:2304
    v_mfma_f32_16x16x32_bf16 v[22:25], v[118:121], v[138:141], v[22:25]
    ds_read_b64 v[54:55], v8 offset:1792
    v_mfma_f32_16x16x32_bf16 v[26:29], v[110:113], v[150:153], v[26:29]
    ds_read_b64 v[56:57], v8 offset:1800
    v_mfma_f32_16x16x32_bf16 v[26:29], v[118:121], v[142:145], v[26:29]
    ds_read_b128 v[90:93], v9 offset:1792
    v_mfma_f32_16x16x32_bf16 v[30:33], v[114:117], v[150:153], v[30:33]
    ds_read_b64 v[58:59], v8 offset:2304
    v_mfma_f32_16x16x32_bf16 v[30:33], v[118:121], v[146:149], v[30:33]
    ds_read_b64 v[60:61], v8 offset:2312
    v_mfma_f32_16x16x32_bf16 v[34:37], v[118:121], v[150:153], v[34:37]
    ds_read_b128 v[94:97], v9 offset:1280
    v_mfma_f32_16x16x32_bf16 v[26:29], v[106:109], v[154:157], v[26:29]
    ds_read_b64 v[62:63], v8 offset:2816
    v_mfma_f32_16x16x32_bf16 v[26:29], v[122:125], v[138:141], v[26:29]
    ds_read_b64 v[64:65], v8 offset:2824
    v_mfma_f32_16x16x32_bf16 v[30:33], v[110:113], v[154:157], v[30:33]
    ds_read_b128 v[98:101], v9 offset:768
    v_mfma_f32_16x16x32_bf16 v[30:33], v[122:125], v[142:145], v[30:33]
    ds_read_b64 v[66:67], v8 offset:3328
    v_mfma_f32_16x16x32_bf16 v[34:37], v[114:117], v[154:157], v[34:37]
    ds_read_b64 v[68:69], v8 offset:3336
    v_mfma_f32_16x16x32_bf16 v[34:37], v[122:125], v[146:149], v[34:37]
    ds_read_b128 v[102:105], v9 offset:256
    v_mfma_f32_16x16x32_bf16 v[38:41], v[118:121], v[154:157], v[38:41]
    ds_read_b64 v[70:71], v8 offset:3840
    v_mfma_f32_16x16x32_bf16 v[38:41], v[122:125], v[150:153], v[38:41]
    ds_read_b64 v[72:73], v8 offset:3848
    v_mfma_f32_16x16x32_bf16 v[30:33], v[106:109], v[158:161], v[30:33]
    v_mfma_f32_16x16x32_bf16 v[30:33], v[126:129], v[138:141], v[30:33]
    v_mfma_f32_16x16x32_bf16 v[34:37], v[110:113], v[158:161], v[34:37]
    v_mfma_f32_16x16x32_bf16 v[34:37], v[126:129], v[142:145], v[34:37]
    v_mfma_f32_16x16x32_bf16 v[38:41], v[114:117], v[158:161], v[38:41]
    v_mfma_f32_16x16x32_bf16 v[38:41], v[126:129], v[146:149], v[38:41]
    v_mfma_f32_16x16x32_bf16 v[34:37], v[106:109], v[162:165], v[34:37]
    v_mfma_f32_16x16x32_bf16 v[34:37], v[130:133], v[138:141], v[34:37]
    v_mfma_f32_16x16x32_bf16 v[38:41], v[110:113], v[162:165], v[38:41]
    v_mfma_f32_16x16x32_bf16 v[38:41], v[130:133], v[142:145], v[38:41]
    v_mfma_f32_16x16x32_bf16 v[38:41], v[106:109], v[166:169], v[38:41]
    v_mfma_f32_16x16x32_bf16 v[38:41], v[134:137], v[138:141], v[38:41]
    s_waitcnt lgkmcnt(0)
    v_mfma_f32_16x16x32_bf16 v[10:13], v[42:45], v[74:77], v[10:13]
    ds_read_b128 v[138:141], v9 offset:3904
    v_mfma_f32_16x16x32_bf16 v[14:17], v[42:45], v[78:81], v[14:17]
    ds_read_b64 v[106:107], v8 offset:320
    v_mfma_f32_16x16x32_bf16 v[14:17], v[46:49], v[74:77], v[14:17]
    ds_read_b64 v[108:109], v8 offset:328
    v_mfma_f32_16x16x32_bf16 v[18:21], v[46:49], v[78:81], v[18:21]
    ds_read_b128 v[142:145], v9 offset:3392
    v_mfma_f32_16x16x32_bf16 v[18:21], v[42:45], v[82:85], v[18:21]
    ds_read_b64 v[110:111], v8 offset:832
    v_mfma_f32_16x16x32_bf16 v[18:21], v[50:53], v[74:77], v[18:21]
    ds_read_b64 v[112:113], v8 offset:840
    v_mfma_f32_16x16x32_bf16 v[22:25], v[46:49], v[82:85], v[22:25]
    ds_read_b128 v[146:149], v9 offset:2880
    v_mfma_f32_16x16x32_bf16 v[22:25], v[50:53], v[78:81], v[22:25]
    ds_read_b64 v[114:115], v8 offset:1344
    v_mfma_f32_16x16x32_bf16 v[26:29], v[50:53], v[82:85], v[26:29]
    ds_read_b64 v[116:117], v8 offset:1352
    v_mfma_f32_16x16x32_bf16 v[22:25], v[42:45], v[86:89], v[22:25]
    ds_read_b128 v[150:153], v9 offset:2368
    v_mfma_f32_16x16x32_bf16 v[22:25], v[54:57], v[74:77], v[22:25]
    ds_read_b64 v[118:119], v8 offset:1856
    v_mfma_f32_16x16x32_bf16 v[26:29], v[46:49], v[86:89], v[26:29]
    ds_read_b64 v[120:121], v8 offset:1864
    v_mfma_f32_16x16x32_bf16 v[26:29], v[54:57], v[78:81], v[26:29]
    ds_read_b128 v[154:157], v9 offset:1856
    v_mfma_f32_16x16x32_bf16 v[30:33], v[50:53], v[86:89], v[30:33]
    ds_read_b64 v[122:123], v8 offset:2368
    v_mfma_f32_16x16x32_bf16 v[30:33], v[54:57], v[82:85], v[30:33]
    ds_read_b64 v[124:125], v8 offset:2376
    v_mfma_f32_16x16x32_bf16 v[34:37], v[54:57], v[86:89], v[34:37]
    ds_read_b128 v[158:161], v9 offset:1344
    v_mfma_f32_16x16x32_bf16 v[26:29], v[42:45], v[90:93], v[26:29]
    ds_read_b64 v[126:127], v8 offset:2880
    v_mfma_f32_16x16x32_bf16 v[26:29], v[58:61], v[74:77], v[26:29]
    ds_read_b64 v[128:129], v8 offset:2888
    v_mfma_f32_16x16x32_bf16 v[30:33], v[46:49], v[90:93], v[30:33]
    ds_read_b128 v[162:165], v9 offset:832
    v_mfma_f32_16x16x32_bf16 v[30:33], v[58:61], v[78:81], v[30:33]
    ds_read_b64 v[130:131], v8 offset:3392
    v_mfma_f32_16x16x32_bf16 v[34:37], v[50:53], v[90:93], v[34:37]
    ds_read_b64 v[132:133], v8 offset:3400
    v_mfma_f32_16x16x32_bf16 v[34:37], v[58:61], v[82:85], v[34:37]
    ds_read_b128 v[166:169], v9 offset:320
    v_mfma_f32_16x16x32_bf16 v[38:41], v[54:57], v[90:93], v[38:41]
    ds_read_b64 v[134:135], v8 offset:3904
    v_mfma_f32_16x16x32_bf16 v[38:41], v[58:61], v[86:89], v[38:41]
    ds_read_b64 v[136:137], v8 offset:3912
    v_mfma_f32_16x16x32_bf16 v[30:33], v[42:45], v[94:97], v[30:33]
    v_mfma_f32_16x16x32_bf16 v[30:33], v[62:65], v[74:77], v[30:33]
    v_mfma_f32_16x16x32_bf16 v[34:37], v[46:49], v[94:97], v[34:37]
    v_mfma_f32_16x16x32_bf16 v[34:37], v[62:65], v[78:81], v[34:37]
    v_mfma_f32_16x16x32_bf16 v[38:41], v[50:53], v[94:97], v[38:41]
    v_mfma_f32_16x16x32_bf16 v[38:41], v[62:65], v[82:85], v[38:41]
    v_mfma_f32_16x16x32_bf16 v[34:37], v[42:45], v[98:101], v[34:37]
    v_mfma_f32_16x16x32_bf16 v[34:37], v[66:69], v[74:77], v[34:37]
    v_mfma_f32_16x16x32_bf16 v[38:41], v[46:49], v[98:101], v[38:41]
    v_mfma_f32_16x16x32_bf16 v[38:41], v[66:69], v[78:81], v[38:41]
    v_mfma_f32_16x16x32_bf16 v[38:41], v[42:45], v[102:105], v[38:41]
    v_mfma_f32_16x16x32_bf16 v[38:41], v[70:73], v[74:77], v[38:41]
    s_waitcnt lgkmcnt(0)
    v_mfma_f32_16x16x32_bf16 v[10:13], v[106:109], v[138:141], v[10:13]
    ds_read_b128 v[74:77], v9 offset:3968
    v_mfma_f32_16x16x32_bf16 v[14:17], v[106:109], v[142:145], v[14:17]
    ds_read_b64 v[42:43], v8 offset:384
    v_mfma_f32_16x16x32_bf16 v[14:17], v[110:113], v[138:141], v[14:17]
    ds_read_b64 v[44:45], v8 offset:392
    v_mfma_f32_16x16x32_bf16 v[18:21], v[110:113], v[142:145], v[18:21]
    ds_read_b128 v[78:81], v9 offset:3456
    v_mfma_f32_16x16x32_bf16 v[18:21], v[106:109], v[146:149], v[18:21]
    ds_read_b64 v[46:47], v8 offset:896
    v_mfma_f32_16x16x32_bf16 v[18:21], v[114:117], v[138:141], v[18:21]
    ds_read_b64 v[48:49], v8 offset:904
    v_mfma_f32_16x16x32_bf16 v[22:25], v[110:113], v[146:149], v[22:25]
    ds_read_b128 v[82:85], v9 offset:2944
    v_mfma_f32_16x16x32_bf16 v[22:25], v[114:117], v[142:145], v[22:25]
    ds_read_b64 v[50:51], v8 offset:1408
    v_mfma_f32_16x16x32_bf16 v[26:29], v[114:117], v[146:149], v[26:29]
    ds_read_b64 v[52:53], v8 offset:1416
    v_mfma_f32_16x16x32_bf16 v[22:25], v[106:109], v[150:153], v[22:25]
    ds_read_b128 v[86:89], v9 offset:2432
    v_mfma_f32_16x16x32_bf16 v[22:25], v[118:121], v[138:141], v[22:25]
    ds_read_b64 v[54:55], v8 offset:1920
    v_mfma_f32_16x16x32_bf16 v[26:29], v[110:113], v[150:153], v[26:29]
    ds_read_b64 v[56:57], v8 offset:1928
    v_mfma_f32_16x16x32_bf16 v[26:29], v[118:121], v[142:145], v[26:29]
    ds_read_b128 v[90:93], v9 offset:1920
    v_mfma_f32_16x16x32_bf16 v[30:33], v[114:117], v[150:153], v[30:33]
    ds_read_b64 v[58:59], v8 offset:2432
    v_mfma_f32_16x16x32_bf16 v[30:33], v[118:121], v[146:149], v[30:33]
    ds_read_b64 v[60:61], v8 offset:2440
    v_mfma_f32_16x16x32_bf16 v[34:37], v[118:121], v[150:153], v[34:37]
    ds_read_b128 v[94:97], v9 offset:1408
    v_mfma_f32_16x16x32_bf16 v[26:29], v[106:109], v[154:157], v[26:29]
    ds_read_b64 v[62:63], v8 offset:2944
    v_mfma_f32_16x16x32_bf16 v[26:29], v[122:125], v[138:141], v[26:29]
    ds_read_b64 v[64:65], v8 offset:2952
    v_mfma_f32_16x16x32_bf16 v[30:33], v[110:113], v[154:157], v[30:33]
    ds_read_b128 v[98:101], v9 offset:896
    v_mfma_f32_16x16x32_bf16 v[30:33], v[122:125], v[142:145], v[30:33]
    ds_read_b64 v[66:67], v8 offset:3456
    v_mfma_f32_16x16x32_bf16 v[34:37], v[114:117], v[154:157], v[34:37]
    ds_read_b64 v[68:69], v8 offset:3464
    v_mfma_f32_16x16x32_bf16 v[34:37], v[122:125], v[146:149], v[34:37]
    ds_read_b128 v[102:105], v9 offset:384
    v_mfma_f32_16x16x32_bf16 v[38:41], v[118:121], v[154:157], v[38:41]
    ds_read_b64 v[70:71], v8 offset:3968
    v_mfma_f32_16x16x32_bf16 v[38:41], v[122:125], v[150:153], v[38:41]
    ds_read_b64 v[72:73], v8 offset:3976
    v_mfma_f32_16x16x32_bf16 v[30:33], v[106:109], v[158:161], v[30:33]
    v_mfma_f32_16x16x32_bf16 v[30:33], v[126:129], v[138:141], v[30:33]
    v_mfma_f32_16x16x32_bf16 v[34:37], v[110:113], v[158:161], v[34:37]
    v_mfma_f32_16x16x32_bf16 v[34:37], v[126:129], v[142:145], v[34:37]
    v_mfma_f32_16x16x32_bf16 v[38:41], v[114:117], v[158:161], v[38:41]
    v_mfma_f32_16x16x32_bf16 v[38:41], v[126:129], v[146:149], v[38:41]
    v_mfma_f32_16x16x32_bf16 v[34:37], v[106:109], v[162:165], v[34:37]
    v_mfma_f32_16x16x32_bf16 v[34:37], v[130:133], v[138:141], v[34:37]
    v_mfma_f32_16x16x32_bf16 v[38:41], v[110:113], v[162:165], v[38:41]
    v_mfma_f32_16x16x32_bf16 v[38:41], v[130:133], v[142:145], v[38:41]
    v_mfma_f32_16x16x32_bf16 v[38:41], v[106:109], v[166:169], v[38:41]
    v_mfma_f32_16x16x32_bf16 v[38:41], v[134:137], v[138:141], v[38:41]
    s_waitcnt lgkmcnt(0)
    v_mfma_f32_16x16x32_bf16 v[10:13], v[42:45], v[74:77], v[10:13]
    ds_read_b128 v[138:141], v9 offset:4032
    v_mfma_f32_16x16x32_bf16 v[14:17], v[42:45], v[78:81], v[14:17]
    ds_read_b64 v[106:107], v8 offset:448
    v_mfma_f32_16x16x32_bf16 v[14:17], v[46:49], v[74:77], v[14:17]
    ds_read_b64 v[108:109], v8 offset:456
    v_mfma_f32_16x16x32_bf16 v[18:21], v[46:49], v[78:81], v[18:21]
    ds_read_b128 v[142:145], v9 offset:3520
    v_mfma_f32_16x16x32_bf16 v[18:21], v[42:45], v[82:85], v[18:21]
    ds_read_b64 v[110:111], v8 offset:960
    v_mfma_f32_16x16x32_bf16 v[18:21], v[50:53], v[74:77], v[18:21]
    ds_read_b64 v[112:113], v8 offset:968
    v_mfma_f32_16x16x32_bf16 v[22:25], v[46:49], v[82:85], v[22:25]
    ds_read_b128 v[146:149], v9 offset:3008
    v_mfma_f32_16x16x32_bf16 v[22:25], v[50:53], v[78:81], v[22:25]
    ds_read_b64 v[114:115], v8 offset:1472
    v_mfma_f32_16x16x32_bf16 v[26:29], v[50:53], v[82:85], v[26:29]
    ds_read_b64 v[116:117], v8 offset:1480
    v_mfma_f32_16x16x32_bf16 v[22:25], v[42:45], v[86:89], v[22:25]
    ds_read_b128 v[150:153], v9 offset:2496
    v_mfma_f32_16x16x32_bf16 v[22:25], v[54:57], v[74:77], v[22:25]
    ds_read_b64 v[118:119], v8 offset:1984
    v_mfma_f32_16x16x32_bf16 v[26:29], v[46:49], v[86:89], v[26:29]
    ds_read_b64 v[120:121], v8 offset:1992
    v_mfma_f32_16x16x32_bf16 v[26:29], v[54:57], v[78:81], v[26:29]
    ds_read_b128 v[154:157], v9 offset:1984
    v_mfma_f32_16x16x32_bf16 v[30:33], v[50:53], v[86:89], v[30:33]
    ds_read_b64 v[122:123], v8 offset:2496
    v_mfma_f32_16x16x32_bf16 v[30:33], v[54:57], v[82:85], v[30:33]
    ds_read_b64 v[124:125], v8 offset:2504
    v_mfma_f32_16x16x32_bf16 v[34:37], v[54:57], v[86:89], v[34:37]
    ds_read_b128 v[158:161], v9 offset:1472
    v_mfma_f32_16x16x32_bf16 v[26:29], v[42:45], v[90:93], v[26:29]
    ds_read_b64 v[126:127], v8 offset:3008
    v_mfma_f32_16x16x32_bf16 v[26:29], v[58:61], v[74:77], v[26:29]
    ds_read_b64 v[128:129], v8 offset:3016
    v_mfma_f32_16x16x32_bf16 v[30:33], v[46:49], v[90:93], v[30:33]
    ds_read_b128 v[162:165], v9 offset:960
    v_mfma_f32_16x16x32_bf16 v[30:33], v[58:61], v[78:81], v[30:33]
    ds_read_b64 v[130:131], v8 offset:3520
    v_mfma_f32_16x16x32_bf16 v[34:37], v[50:53], v[90:93], v[34:37]
    ds_read_b64 v[132:133], v8 offset:3528
    v_mfma_f32_16x16x32_bf16 v[34:37], v[58:61], v[82:85], v[34:37]
    ds_read_b128 v[166:169], v9 offset:448
    v_mfma_f32_16x16x32_bf16 v[38:41], v[54:57], v[90:93], v[38:41]
    ds_read_b64 v[134:135], v8 offset:4032
    v_mfma_f32_16x16x32_bf16 v[38:41], v[58:61], v[86:89], v[38:41]
    ds_read_b64 v[136:137], v8 offset:4040
    v_mfma_f32_16x16x32_bf16 v[30:33], v[42:45], v[94:97], v[30:33]
    v_mfma_f32_16x16x32_bf16 v[30:33], v[62:65], v[74:77], v[30:33]
    v_mfma_f32_16x16x32_bf16 v[34:37], v[46:49], v[94:97], v[34:37]
    v_mfma_f32_16x16x32_bf16 v[34:37], v[62:65], v[78:81], v[34:37]
    v_mfma_f32_16x16x32_bf16 v[38:41], v[50:53], v[94:97], v[38:41]
    v_mfma_f32_16x16x32_bf16 v[38:41], v[62:65], v[82:85], v[38:41]
    v_mfma_f32_16x16x32_bf16 v[34:37], v[42:45], v[98:101], v[34:37]
    v_mfma_f32_16x16x32_bf16 v[34:37], v[66:69], v[74:77], v[34:37]
    v_mfma_f32_16x16x32_bf16 v[38:41], v[46:49], v[98:101], v[38:41]
    v_mfma_f32_16x16x32_bf16 v[38:41], v[66:69], v[78:81], v[38:41]
    v_mfma_f32_16x16x32_bf16 v[38:41], v[42:45], v[102:105], v[38:41]
    v_mfma_f32_16x16x32_bf16 v[38:41], v[70:73], v[74:77], v[38:41]
    s_waitcnt lgkmcnt(0)
    v_mfma_f32_16x16x32_bf16 v[10:13], v[106:109], v[138:141], v[10:13]
    v_mfma_f32_16x16x32_bf16 v[14:17], v[106:109], v[142:145], v[14:17]
    v_mfma_f32_16x16x32_bf16 v[14:17], v[110:113], v[138:141], v[14:17]
    v_mfma_f32_16x16x32_bf16 v[18:21], v[110:113], v[142:145], v[18:21]
    v_mfma_f32_16x16x32_bf16 v[18:21], v[106:109], v[146:149], v[18:21]
    v_mfma_f32_16x16x32_bf16 v[18:21], v[114:117], v[138:141], v[18:21]
    v_mfma_f32_16x16x32_bf16 v[22:25], v[110:113], v[146:149], v[22:25]
    v_mfma_f32_16x16x32_bf16 v[22:25], v[114:117], v[142:145], v[22:25]
    v_mfma_f32_16x16x32_bf16 v[26:29], v[114:117], v[146:149], v[26:29]
    v_mfma_f32_16x16x32_bf16 v[22:25], v[106:109], v[150:153], v[22:25]
    v_mfma_f32_16x16x32_bf16 v[22:25], v[118:121], v[138:141], v[22:25]
    v_mfma_f32_16x16x32_bf16 v[26:29], v[110:113], v[150:153], v[26:29]
    v_mfma_f32_16x16x32_bf16 v[26:29], v[118:121], v[142:145], v[26:29]
    v_mfma_f32_16x16x32_bf16 v[30:33], v[114:117], v[150:153], v[30:33]
    v_mfma_f32_16x16x32_bf16 v[30:33], v[118:121], v[146:149], v[30:33]
    v_mfma_f32_16x16x32_bf16 v[34:37], v[118:121], v[150:153], v[34:37]
    v_mfma_f32_16x16x32_bf16 v[26:29], v[106:109], v[154:157], v[26:29]
    v_mfma_f32_16x16x32_bf16 v[26:29], v[122:125], v[138:141], v[26:29]
    v_mfma_f32_16x16x32_bf16 v[30:33], v[110:113], v[154:157], v[30:33]
    v_mfma_f32_16x16x32_bf16 v[30:33], v[122:125], v[142:145], v[30:33]
    v_mfma_f32_16x16x32_bf16 v[34:37], v[114:117], v[154:157], v[34:37]
    v_mfma_f32_16x16x32_bf16 v[34:37], v[122:125], v[146:149], v[34:37]
    v_mfma_f32_16x16x32_bf16 v[38:41], v[118:121], v[154:157], v[38:41]
    v_mfma_f32_16x16x32_bf16 v[38:41], v[122:125], v[150:153], v[38:41]
    v_mfma_f32_16x16x32_bf16 v[30:33], v[106:109], v[158:161], v[30:33]
    v_mfma_f32_16x16x32_bf16 v[30:33], v[126:129], v[138:141], v[30:33]
    v_mfma_f32_16x16x32_bf16 v[34:37], v[110:113], v[158:161], v[34:37]
    v_mfma_f32_16x16x32_bf16 v[34:37], v[126:129], v[142:145], v[34:37]
    v_mfma_f32_16x16x32_bf16 v[38:41], v[114:117], v[158:161], v[38:41]
    v_mfma_f32_16x16x32_bf16 v[38:41], v[126:129], v[146:149], v[38:41]
    v_mfma_f32_16x16x32_bf16 v[34:37], v[106:109], v[162:165], v[34:37]
    v_mfma_f32_16x16x32_bf16 v[34:37], v[130:133], v[138:141], v[34:37]
    v_mfma_f32_16x16x32_bf16 v[38:41], v[110:113], v[162:165], v[38:41]
    v_mfma_f32_16x16x32_bf16 v[38:41], v[130:133], v[142:145], v[38:41]
    v_mfma_f32_16x16x32_bf16 v[38:41], v[106:109], v[166:169], v[38:41]
    v_mfma_f32_16x16x32_bf16 v[38:41], v[134:137], v[138:141], v[38:41]
    s_lshl_b32 s56, s58, 12
    s_add_u32 s56, s56, 117760
    v_add_u32 v6, s56, v1
    ds_write_b128 v6, v[26:29] offset:0
    ds_write_b128 v6, v[30:33] offset:1024
    ds_write_b128 v6, v[34:37] offset:2048
    s_nop 1
    ds_write_b128 v6, v[38:41] offset:3072
    s_waitcnt lgkmcnt(0)
    s_barrier
    s_branch L_c_epi_11
L_c_help_9:
    s_and_b32 s56, s53, 1
    s_lshl_b32 s56, s56, 3
    s_and_b32 s57, s54, 7
    s_add_u32 s60, s56, s57
    s_lshr_b32 s56, s53, 1
    s_lshl_b32 s56, s56, 2
    s_lshr_b32 s57, s54, 3
    s_add_u32 s61, s56, s57
    s_sub_u32 s58, s52, 4
    v_lshrrev_b32 v13, 4, v0
    v_and_b32 v14, 15, v0
    v_lshrrev_b32 v15, 1, v14
    v_and_b32 v16, 1, v14
    v_xor_b32 v15, v15, v13
    s_lshl_b32 s59, s58, 4
    v_add_u32 v17, s59, v13
    v_lshlrev_b32 v17, 8, v17
    v_lshl_add_u32 v17, v16, 4, v17
    s_lshl_b32 s59, s60, 18
    s_add_u32 s59, s59, 9437184
    v_add_u32 v17, s59, v17
    v_xor_b32 v18, 0, v15
    v_lshl_add_u32 v18, v18, 5, v17
    v_add_u32 v200, 0, v18
    v_xor_b32 v18, 0, v15
    v_lshl_add_u32 v18, v18, 5, v17
    v_add_u32 v201, 1024, v18
    v_xor_b32 v18, 4, v15
    v_lshl_add_u32 v18, v18, 5, v17
    v_add_u32 v202, 2048, v18
    v_xor_b32 v18, 4, v15
    v_lshl_add_u32 v18, v18, 5, v17
    v_add_u32 v203, 3072, v18
    s_mov_b32 s59, 0x924924a
    v_add_u32 v13, 0, v0
    v_mul_hi_u32 v14, s59, v13
    v_mul_u32_u24 v15, 28, v14
    v_sub_u32 v15, v13, v15
    v_bfe_u32 v16, v14, 3, 1
    v_lshrrev_b32 v17, 1, v15
    v_xor_b32 v17, v17, v16
    v_and_b32 v15, 1, v15
    v_lshlrev_b32 v15, 4, v15
    v_lshl_add_u32 v15, v17, 5, v15
    v_mul_u32_u24 v14, 7168, v14
    v_add_u32 v204, v14, v15
    v_add_u32 v13, 64, v0
    v_mul_hi_u32 v14, s59, v13
    v_mul_u32_u24 v15, 28, v14
    v_sub_u32 v15, v13, v15
    v_bfe_u32 v16, v14, 3, 1
    v_lshrrev_b32 v17, 1, v15
    v_xor_b32 v17, v17, v16
    v_and_b32 v15, 1, v15
    v_lshlrev_b32 v15, 4, v15
    v_lshl_add_u32 v15, v17, 5, v15
    v_mul_u32_u24 v14, 7168, v14
    v_add_u32 v205, v14, v15
    v_add_u32 v13, 128, v0
    v_mul_hi_u32 v14, s59, v13
    v_mul_u32_u24 v15, 28, v14
    v_sub_u32 v15, v13, v15
    v_bfe_u32 v16, v14, 3, 1
    v_lshrrev_b32 v17, 1, v15
    v_xor_b32 v17, v17, v16
    v_and_b32 v15, 1, v15
    v_lshlrev_b32 v15, 4, v15
    v_lshl_add_u32 v15, v17, 5, v15
    v_mul_u32_u24 v14, 7168, v14
    v_add_u32 v206, v14, v15
    v_add_u32 v13, 192, v0
    v_mul_hi_u32 v14, s59, v13
    v_mul_u32_u24 v15, 28, v14
    v_sub_u32 v15, v13, v15
    v_bfe_u32 v16, v14, 3, 1
    v_lshrrev_b32 v17, 1, v15
    v_xor_b32 v17, v17, v16
    v_and_b32 v15, 1, v15
    v_lshlrev_b32 v15, 4, v15
    v_lshl_add_u32 v15, v17, 5, v15
    v_mul_u32_u24 v14, 7168, v14
    v_add_u32 v207, v14, v15
    v_add_u32 v13, 256, v0
    v_mul_hi_u32 v14, s59, v13
    v_mul_u32_u24 v15, 28, v14
    v_sub_u32 v15, v13, v15
    v_bfe_u32 v16, v14, 3, 1
    v_lshrrev_b32 v17, 1, v15
    v_xor_b32 v17, v17, v16
    v_and_b32 v15, 1, v15
    v_lshlrev_b32 v15, 4, v15
    v_lshl_add_u32 v15, v17, 5, v15
    v_mul_u32_u24 v14, 7168, v14
    v_add_u32 v208, v14, v15
    v_add_u32 v13, 320, v0
    v_mul_hi_u32 v14, s59, v13
    v_mul_u32_u24 v15, 28, v14
    v_sub_u32 v15, v13, v15
    v_bfe_u32 v16, v14, 3, 1
    v_lshrrev_b32 v17, 1, v15
    v_xor_b32 v17, v17, v16
    v_and_b32 v15, 1, v15
    v_lshlrev_b32 v15, 4, v15
    v_lshl_add_u32 v15, v17, 5, v15
    v_mul_u32_u24 v14, 7168, v14
    v_add_u32 v209, v14, v15
    v_add_u32 v13, 384, v0
    v_mul_hi_u32 v14, s59, v13
    v_mul_u32_u24 v15, 28, v14
    v_sub_u32 v15, v13, v15
    v_bfe_u32 v16, v14, 3, 1
    v_lshrrev_b32 v17, 1, v15
    v_xor_b32 v17, v17, v16
    v_and_b32 v15, 1, v15
    v_lshlrev_b32 v15, 4, v15
    v_lshl_add_u32 v15, v17, 5, v15
    v_mul_u32_u24 v14, 7168, v14
    v_add_u32 v210, v14, v15
    s_mul_i32 s59, s58, 16*7168
    s_mul_i32 s57, s61, 448
    s_add_u32 s59, s59, s57
    v_add_u32 v204, s59, v204
    v_add_u32 v205, s59, v205
    v_add_u32 v206, s59, v206
    v_add_u32 v207, s59, v207
    v_add_u32 v208, s59, v208
    v_add_u32 v209, s59, v209
    v_add_u32 v210, s59, v210
    s_and_b32 s58, s52, 3
    s_lshl_b32 s56, s53, 7
    s_lshl_b32 s57, s54, 2
    s_add_u32 s56, s56, s57
    s_add_u32 s63, s56, s58
    v_lshlrev_b32 v1, 4, v0
    s_cmp_eq_u32 s52, 4
    s_cbranch_scc0 L_c_q_21
    s_add_u32 s56, s55, 1
    v_lshlrev_b32 v252, 7, v0
    v_add_u32 v252, 8192, v252
    s_mov_b32 s57, 0x200000
L_poll_25:
    s_sleep 8
    buffer_load_dwordx4 v[248:251], v252, s[36:39], 0 offen sc1
    s_sub_u32 s57, s57, 1
    s_cmp_eq_u32 s57, 0
    s_cbranch_scc1 L_pollx_26
    s_waitcnt vmcnt(0)
    v_subrev_u32 v248, s56, v248
    v_subrev_u32 v249, s56, v249
    v_subrev_u32 v250, s56, v250
    v_subrev_u32 v251, s56, v251
    v_max_u32 v248, v248, v249
    v_max3_u32 v248, v248, v250, v251
    v_cmp_le_u32 vcc, 16, v248
    s_cbranch_vccnz L_poll_25
L_pollx_26:
    s_waitcnt vmcnt(0)
    s_mov_b32 s60, 65536
    s_mov_b32 m0, 84992
    s_nop 0
    buffer_load_dwordx4 v1, s[36:39], s60 offen sc1 lds
    s_add_u32 m0, m0, 1024
    s_add_u32 s60, s60, 1024
    buffer_load_dwordx4 v1, s[36:39], s60 offen sc1 lds
    s_add_u32 m0, m0, 1024
    s_add_u32 s60, s60, 1024
    buffer_load_dwordx4 v1, s[36:39], s60 offen sc1 lds
    s_add_u32 m0, m0, 1024
    s_add_u32 s60, s60, 1024
    buffer_load_dwordx4 v1, s[36:39], s60 offen sc1 lds
    s_add_u32 m0, m0, 1024
    s_add_u32 s60, s60, 1024
    buffer_load_dwordx4 v1, s[36:39], s60 offen sc1 lds
    s_add_u32 m0, m0, 1024
    s_add_u32 s60, s60, 1024
    buffer_load_dwordx4 v1, s[36:39], s60 offen sc1 lds
    s_add_u32 m0, m0, 1024
    s_add_u32 s60, s60, 1024
    buffer_load_dwordx4 v1, s[36:39], s60 offen sc1 lds
    s_add_u32 m0, m0, 1024
    s_add_u32 s60, s60, 1024
    buffer_load_dwordx4 v1, s[36:39], s60 offen sc1 lds
    s_add_u32 m0, m0, 1024
    s_add_u32 s60, s60, 1024
    buffer_load_dwordx4 v1, s[36:39], s60 offen sc1 lds
    s_add_u32 m0, m0, 1024
    s_add_u32 s60, s60, 1024
    buffer_load_dwordx4 v1, s[36:39], s60 offen sc1 lds
    s_add_u32 m0, m0, 1024
    s_add_u32 s60, s60, 1024
    buffer_load_dwordx4 v1, s[36:39], s60 offen sc1 lds
    s_add_u32 m0, m0, 1024
    s_add_u32 s60, s60, 1024
    buffer_load_dwordx4 v1, s[36:39], s60 offen sc1 lds
    s_add_u32 m0, m0, 1024
    s_add_u32 s60, s60, 1024
    buffer_load_dwordx4 v1, s[36:39], s60 offen sc1 lds
    s_add_u32 m0, m0, 1024
    s_add_u32 s60, s60, 1024
    buffer_load_dwordx4 v1, s[36:39], s60 offen sc1 lds
    s_add_u32 m0, m0, 1024
    s_add_u32 s60, s60, 1024
    buffer_load_dwordx4 v1, s[36:39], s60 offen sc1 lds
    s_add_u32 m0, m0, 1024
    s_add_u32 s60, s60, 1024
    buffer_load_dwordx4 v1, s[36:39], s60 offen sc1 lds
    v_mov_b32 v250, 150560
    s_mov_b32 s57, 0x400000
L_lw_27:
    ds_read_b32 v251, v250
    s_sub_u32 s57, s57, 1
    s_cmp_eq_u32 s57, 0
    s_cbranch_scc1 L_lwx_28
    s_waitcnt lgkmcnt(0)
    v_readfirstlane_b32 s56, v251
    s_nop 0
    s_cmp_lt_u32 s56, 1
    s_cbranch_scc1 L_lw_27
L_lwx_28:
    s_waitcnt lgkmcnt(0)
    s_branch L_c_x_23
L_c_q_21:
    s_cmp_eq_u32 s52, 5
    s_cbranch_scc0 L_c_w5_24
    s_add_u32 s56, s55, 1
    v_and_b32 v252, 7, v0
    v_lshlrev_b32 v252, 7, v252
    s_lshl_b32 s57, s53, 10
    s_add_u32 s57, s57, 16384
    v_add_u32 v252, s57, v252
    s_mov_b32 s57, 0x200000
L_pollg_29:
    s_sleep 4
    s_mov_b64 exec, 0xff
    buffer_load_dwordx4 v[248:251], v252, s[36:39], 0 offen sc1
    s_sub_u32 s57, s57, 1
    s_cmp_eq_u32 s57, 0
    s_cbranch_scc1 L_pollgx_30
    s_waitcnt vmcnt(0)
    v_subrev_u32 v248, s56, v248
    v_subrev_u32 v249, s56, v249
    v_subrev_u32 v250, s56, v250
    v_subrev_u32 v251, s56, v251
    v_max_u32 v248, v248, v249
    v_max3_u32 v248, v248, v250, v251
    v_cmp_le_u32 vcc, 16, v248
    s_cbranch_vccnz L_pollg_29
L_pollgx_30:
    s_waitcnt vmcnt(0)
    s_mov_b64 exec, -1
    v_mov_b32 v250, 150560
    v_mov_b32 v251, 1
    s_mov_b64 exec, 1
    ds_add_rtn_u32 v252, v250, v251
    s_waitcnt lgkmcnt(0)
    v_readfirstlane_b32 s56, v252
    s_mov_b64 exec, -1
    s_branch L_c_x_23
L_c_w5_24:
    v_mov_b32 v250, 150560
    s_mov_b32 s57, 0x400000
L_lw_32:
    ds_read_b32 v251, v250
    s_sub_u32 s57, s57, 1
    s_cmp_eq_u32 s57, 0
    s_cbranch_scc1 L_lwx_33
    s_waitcnt lgkmcnt(0)
    v_readfirstlane_b32 s56, v251
    s_nop 0
    s_cmp_lt_u32 s56, 1
    s_cbranch_scc1 L_lw_32
L_lwx_33:
    s_waitcnt lgkmcnt(0)
L_c_x_23:
    s_lshl_b32 s56, s63, 12
    s_add_u32 s60, s56, 5242880
    s_lshl_b32 s56, s58, 12
    s_add_u32 m0, s56, 134144
    s_nop 0
    buffer_load_dwordx4 v1, s[36:39], s60 offen sc1 lds
    s_add_u32 m0, m0, 1024
    s_add_u32 s60, s60, 1024
    buffer_load_dwordx4 v1, s[36:39], s60 offen sc1 lds
    s_add_u32 m0, m0, 1024
    s_add_u32 s60, s60, 1024
    buffer_load_dwordx4 v1, s[36:39], s60 offen sc1 lds
    s_add_u32 m0, m0, 1024
    s_add_u32 s60, s60, 1024
    buffer_load_dwordx4 v1, s[36:39], s60 offen sc1 lds
    s_waitcnt vmcnt(0)
L_c_q2_22:
    s_barrier
    s_and_b32 s58, s52, 3
    s_lshl_b32 s56, s53, 7
    s_lshl_b32 s57, s54, 2
    s_add_u32 s56, s56, s57
    s_add_u32 s63, s56, s58
    v_lshlrev_b32 v1, 4, v0
    v_and_b32 v2, 15, v0
    v_lshrrev_b32 v3, 4, v0
    s_lshl_b32 s56, s58, 12
    s_add_u32 s56, s56, 117760
    v_add_u32 v6, s56, v1
    ds_read_b128 v[10:13], v6 offset:0
    ds_read_b128 v[14:17], v6 offset:1024
    ds_read_b128 v[18:21], v6 offset:2048
    ds_read_b128 v[22:25], v6 offset:3072
L_c_epi_11:
    s_lshr_b32 s59, s52, 2
    v_and_b32 v4, 1, v3
    s_lshl_b32 s56, s59, 2
    v_add_u32 v4, s56, v4
    v_lshlrev_b32 v4, 8, v4
    v_lshl_add_u32 v4, v2, 4, v4
    v_lshrrev_b32 v5, 1, v3
    v_lshl_add_u32 v4, v5, 3, v4
    v_sub_u32 v5, 2040, v4
    v_lshlrev_b32 v5, 1, v5
    s_mul_i32 s56, s58, 4608
    s_add_u32 s56, s56, 65536
    v_add_u32 v5, s56, v5
    ds_read_b128 v[42:45], v5 offset:1024
    ds_read_b128 v[46:49], v5
    s_lshl_b32 s56, s58, 12
    s_add_u32 s56, s56, 134144
    v_lshl_add_u32 v5, v4, 1, s56
    ds_read_b128 v[82:85], v5
    ds_read_b128 v[86:89], v5 offset:1024
    v_lshlrev_b32 v5, 3, v4
    v_add_u32 v5, 84992, v5
    ds_read_b128 v[50:53], v5 offset:0
    ds_read_b128 v[54:57], v5 offset:16
    ds_read_b128 v[58:61], v5 offset:32
    ds_read_b128 v[62:65], v5 offset:48
    ds_read_b128 v[66:69], v5 offset:4096
    ds_read_b128 v[70:73], v5 offset:4112
    ds_read_b128 v[74:77], v5 offset:4128
    ds_read_b128 v[78:81], v5 offset:4144
    v_lshrrev_b32 v5, 7, v4
    v_lshlrev_b32 v5, 18, v5
    v_and_b32 v6, 127, v4
    v_lshl_add_u32 v5, v6, 1, v5
    s_lshl_b32 s56, s63, 8
    s_add_u32 s60, s56, 9437184
    s_add_u32 s62, s60, 1048576
    s_and_b32 s56, s63, 1
    s_lshl_b32 s56, s56, 4
    s_lshr_b32 s61, s69, s56
    s_lshl_b32 s61, s61, 16
    s_waitcnt lgkmcnt(0)
    v_permlane16_swap_b32 v10, v14
    v_permlane16_swap_b32 v11, v15
    v_permlane16_swap_b32 v12, v16
    v_permlane16_swap_b32 v13, v17
    v_lshlrev_b32 v126, 16, v82
    v_and_b32 v127, 0xffff0000, v45
    v_fmac_f32 v10, s61, v127
    v_sub_f32 v128, v126, v50
    v_mul_f32 v128, v128, v51
    v_fma_f32 v110, v128, v10, v126
    v_and_b32 v130, 0xffff0000, v82
    v_lshlrev_b32 v131, 16, v45
    v_fmac_f32 v11, s61, v131
    v_sub_f32 v132, v130, v52
    v_mul_f32 v132, v132, v53
    v_fma_f32 v111, v132, v11, v130
    v_lshlrev_b32 v126, 16, v83
    v_and_b32 v127, 0xffff0000, v44
    v_fmac_f32 v12, s61, v127
    v_sub_f32 v128, v126, v54
    v_mul_f32 v128, v128, v55
    v_fma_f32 v112, v128, v12, v126
    v_and_b32 v130, 0xffff0000, v83
    v_lshlrev_b32 v131, 16, v44
    v_fmac_f32 v13, s61, v131
    v_sub_f32 v132, v130, v56
    v_mul_f32 v132, v132, v57
    v_fma_f32 v113, v132, v13, v130
    v_lshlrev_b32 v126, 16, v84
    v_and_b32 v127, 0xffff0000, v43
    v_fmac_f32 v14, s61, v127
    v_sub_f32 v128, v126, v58
    v_mul_f32 v128, v128, v59
    v_fma_f32 v114, v128, v14, v126
    v_and_b32 v130, 0xffff0000, v84
    v_lshlrev_b32 v131, 16, v43
    v_fmac_f32 v15, s61, v131
    v_sub_f32 v132, v130, v60
    v_mul_f32 v132, v132, v61
    v_fma_f32 v115, v132, v15, v130
    v_lshlrev_b32 v126, 16, v85
    v_and_b32 v127, 0xffff0000, v42
    v_fmac_f32 v16, s61, v127
    v_sub_f32 v128, v126, v62
    v_mul_f32 v128, v128, v63
    v_fma_f32 v116, v128, v16, v126
    v_and_b32 v130, 0xffff0000, v85
    v_lshlrev_b32 v131, 16, v42
    v_fmac_f32 v17, s61, v131
    v_sub_f32 v132, v130, v64
    v_mul_f32 v132, v132, v65
    v_fma_f32 v117, v132, v17, v130
    v_cvt_pk_bf16_f32 v118, v110, v111
    v_cvt_pk_bf16_f32 v119, v112, v113
    v_cvt_pk_bf16_f32 v120, v114, v115
    v_cvt_pk_bf16_f32 v121, v116, v117
    buffer_store_dwordx4 v[118:121], v5, s[36:39], s60 offen sc1
    v_permlane16_swap_b32 v18, v22
    v_permlane16_swap_b32 v19, v23
    v_permlane16_swap_b32 v20, v24
    v_permlane16_swap_b32 v21, v25
    v_lshlrev_b32 v156, 16, v86
    v_and_b32 v157, 0xffff0000, v49
    v_fmac_f32 v18, s61, v157
    v_sub_f32 v158, v156, v66
    v_mul_f32 v158, v158, v67
    v_fma_f32 v140, v158, v18, v156
    v_and_b32 v160, 0xffff0000, v86
    v_lshlrev_b32 v161, 16, v49
    v_fmac_f32 v19, s61, v161
    v_sub_f32 v162, v160, v68
    v_mul_f32 v162, v162, v69
    v_fma_f32 v141, v162, v19, v160
    v_lshlrev_b32 v156, 16, v87
    v_and_b32 v157, 0xffff0000, v48
    v_fmac_f32 v20, s61, v157
    v_sub_f32 v158, v156, v70
    v_mul_f32 v158, v158, v71
    v_fma_f32 v142, v158, v20, v156
    v_and_b32 v160, 0xffff0000, v87
    v_lshlrev_b32 v161, 16, v48
    v_fmac_f32 v21, s61, v161
    v_sub_f32 v162, v160, v72
    v_mul_f32 v162, v162, v73
    v_fma_f32 v143, v162, v21, v160
    v_lshlrev_b32 v156, 16, v88
    v_and_b32 v157, 0xffff0000, v47
    v_fmac_f32 v22, s61, v157
    v_sub_f32 v158, v156, v74
    v_mul_f32 v158, v158, v75
    v_fma_f32 v144, v158, v22, v156
    v_and_b32 v160, 0xffff0000, v88
    v_lshlrev_b32 v161, 16, v47
    v_fmac_f32 v23, s61, v161
    v_sub_f32 v162, v160, v76
    v_mul_f32 v162, v162, v77
    v_fma_f32 v145, v162, v23, v160
    v_lshlrev_b32 v156, 16, v89
    v_and_b32 v157, 0xffff0000, v46
    v_fmac_f32 v24, s61, v157
    v_sub_f32 v158, v156, v78
    v_mul_f32 v158, v158, v79
    v_fma_f32 v146, v158, v24, v156
    v_and_b32 v160, 0xffff0000, v89
    v_lshlrev_b32 v161, 16, v46
    v_fmac_f32 v25, s61, v161
    v_sub_f32 v162, v160, v80
    v_mul_f32 v162, v162, v81
    v_fma_f32 v147, v162, v25, v160
    v_cvt_pk_bf16_f32 v148, v140, v141
    v_cvt_pk_bf16_f32 v149, v142, v143
    v_cvt_pk_bf16_f32 v150, v144, v145
    v_cvt_pk_bf16_f32 v151, v146, v147
    buffer_store_dwordx4 v[148:151], v5, s[36:39], s62 offen sc1
    s_waitcnt vmcnt(0) lgkmcnt(0)
    s_barrier
    s_cmp_lg_u32 s52, 0
    s_cbranch_scc1 L_sig_34
    s_add_u32 s56, s55, 3
    v_mov_b32 v254, s56
    s_lshl_b32 s57, s53, 10
    s_lshr_b32 s56, s54, 2
    s_lshl_b32 s56, s56, 7
    s_add_u32 s57, s57, s56
    s_and_b32 s56, s54, 3
    s_lshl_b32 s56, s56, 2
    s_add_u32 s57, s57, s56
    v_mov_b32 v255, s57
    s_mov_b64 exec, 1
    buffer_store_dword v254, v255, s[36:39], 0 offen sc1
    s_mov_b64 exec, -1
L_sig_34:
    s_and_b32 s56, s53, 1
    s_lshl_b32 s56, s56, 3
    s_and_b32 s57, s54, 7
    s_add_u32 s60, s56, s57
    s_lshr_b32 s56, s53, 1
    s_lshl_b32 s56, s56, 2
    s_lshr_b32 s57, s54, 3
    s_add_u32 s61, s56, s57
    s_cmp_lt_u32 s52, 4
    s_cbranch_scc1 L_g1comp_35
    s_mov_b32 s44, s22
    s_mov_b32 s45, s23
    s_mov_b32 s46, 7340032
    s_mov_b32 s47, 0x20000
    s_sub_u32 s58, s52, 4
    s_lshl_b32 s62, s58, 12
    s_mul_i32 s63, s58, 7168
    s_add_u32 s63, s63, 16384
    s_mul_i32 s68, s60, 9
    s_mul_i32 s56, s61, 1
    s_add_u32 s68, s68, s56
    s_sub_u32 s68, s68, 1
    s_add_u32 s68, s68, 1
    s_and_b32 s68, s68, 15
    s_mul_i32 s65, s68, 458752
    s_lshl_b32 s66, s68, 14
    s_mov_b32 s64, 0
    s_add_u32 m0, s64, s63
    s_nop 0
    buffer_load_dwordx4 v204, s[44:47], s65 offen lds
    s_add_u32 m0, m0, 1024
    s_nop 0
    buffer_load_dwordx4 v205, s[44:47], s65 offen lds
    s_add_u32 m0, m0, 1024
    s_nop 0
    buffer_load_dwordx4 v206, s[44:47], s65 offen lds
    s_add_u32 m0, m0, 1024
    s_nop 0
    buffer_load_dwordx4 v207, s[44:47], s65 offen lds
    s_add_u32 m0, m0, 1024
    s_nop 0
    buffer_load_dwordx4 v208, s[44:47], s65 offen lds
    s_add_u32 m0, m0, 1024
    s_nop 0
    buffer_load_dwordx4 v209, s[44:47], s65 offen lds
    s_add_u32 m0, m0, 1024
    s_nop 0
    buffer_load_dwordx4 v210, s[44:47], s65 offen lds
    s_mov_b32 s88, s66
    s_add_u32 s68, s68, 1
    s_and_b32 s68, s68, 15
    s_mul_i32 s65, s68, 458752
    s_lshl_b32 s66, s68, 14
    s_mov_b32 s64, 45056
    s_add_u32 m0, s64, s63
    s_nop 0
    buffer_load_dwordx4 v204, s[44:47], s65 offen lds
    s_add_u32 m0, m0, 1024
    s_nop 0
    buffer_load_dwordx4 v205, s[44:47], s65 offen lds
    s_add_u32 m0, m0, 1024
    s_nop 0
    buffer_load_dwordx4 v206, s[44:47], s65 offen lds
    s_add_u32 m0, m0, 1024
    s_nop 0
    buffer_load_dwordx4 v207, s[44:47], s65 offen lds
    s_add_u32 m0, m0, 1024
    s_nop 0
    buffer_load_dwordx4 v208, s[44:47], s65 offen lds
    s_add_u32 m0, m0, 1024
    s_nop 0
    buffer_load_dwordx4 v209, s[44:47], s65 offen lds
    s_add_u32 m0, m0, 1024
    s_nop 0
    buffer_load_dwordx4 v210, s[44:47], s65 offen lds
    s_waitcnt vmcnt(7)
    s_barrier
    v_lshrrev_b32 v20, 4, v0
    v_and_b32 v21, 15, v0
    v_lshrrev_b32 v22, 2, v21
    v_and_b32 v23, 3, v21
    v_lshl_add_u32 v24, v20, 3, v22
    v_and_b32 v25, 1, v20
    v_mul_u32_u24 v27, 448, v24
    v_lshl_add_u32 v27, v23, 3, v27
    v_add_u32 v27, 16384, v27
    s_add_u32 s56, s58, 0
    s_min_u32 s56, s56, 13
    s_mov_b32 s84, s56
    v_xor_b32 v28, s56, v25
    v_lshl_add_u32 v116, v28, 5, v27
    s_add_u32 s56, s58, 4
    s_min_u32 s56, s56, 13
    s_mov_b32 s85, s56
    v_xor_b32 v28, s56, v25
    v_lshl_add_u32 v117, v28, 5, v27
    s_add_u32 s56, s58, 8
    s_min_u32 s56, s56, 13
    s_mov_b32 s86, s56
    v_xor_b32 v28, s56, v25
    v_lshl_add_u32 v118, v28, 5, v27
    s_add_u32 s56, s58, 12
    s_min_u32 s56, s56, 13
    s_mov_b32 s87, s56
    v_xor_b32 v28, s56, v25
    v_lshl_add_u32 v119, v28, 5, v27
    ds_read_b64_tr_b16 v[48:49], v116 offset:0
    ds_read_b64_tr_b16 v[50:51], v116 offset:1792
    ds_read_b64_tr_b16 v[52:53], v116 offset:14336
    ds_read_b64_tr_b16 v[54:55], v116 offset:16128
    ds_read_b64_tr_b16 v[56:57], v117 offset:0
    ds_read_b64_tr_b16 v[58:59], v117 offset:1792
    ds_read_b64_tr_b16 v[60:61], v117 offset:14336
    ds_read_b64_tr_b16 v[62:63], v117 offset:16128
    ds_read_b64_tr_b16 v[64:65], v118 offset:0
    ds_read_b64_tr_b16 v[66:67], v118 offset:1792
    ds_read_b64_tr_b16 v[68:69], v118 offset:14336
    ds_read_b64_tr_b16 v[70:71], v118 offset:16128
    ds_read_b64_tr_b16 v[72:73], v119 offset:0
    ds_read_b64_tr_b16 v[74:75], v119 offset:1792
    ds_read_b64_tr_b16 v[76:77], v119 offset:14336
    ds_read_b64_tr_b16 v[78:79], v119 offset:16128
    v_mov_b32 v80, 0x3f803f80
    v_mov_b32 v81, 0x3f803f80
    v_mov_b32 v82, 0x3f803f80
    v_mov_b32 v83, 0x3f803f80
    s_waitcnt lgkmcnt(0)
    s_nop 0
    v_mfma_f32_16x16x32_bf16 v[100:103], v[48:51], v[80:83], 0
    v_mfma_f32_16x16x32_bf16 v[104:107], v[56:59], v[80:83], 0
    v_mfma_f32_16x16x32_bf16 v[108:111], v[64:67], v[80:83], 0
    v_mfma_f32_16x16x32_bf16 v[112:115], v[72:75], v[80:83], 0
    v_mfma_f32_16x16x32_bf16 v[100:103], v[52:55], v[80:83], v[100:103]
    v_mfma_f32_16x16x32_bf16 v[104:107], v[60:63], v[80:83], v[104:107]
    v_mfma_f32_16x16x32_bf16 v[108:111], v[68:71], v[80:83], v[108:111]
    v_mfma_f32_16x16x32_bf16 v[112:115], v[76:79], v[80:83], v[112:115]
    s_lshl_b32 s56, s61, 4
    s_add_u32 s56, s56, s60
    s_lshl_b32 s56, s56, 10
    s_add_u32 s56, s56, 393216
    v_lshl_add_u32 v28, v20, 4, s56
    s_mov_b32 exec_lo, 0x00010001
    s_mov_b32 exec_hi, 0x00010001
    s_lshl_b32 s56, s84, 6
    buffer_store_dwordx4 v[100:103], v28, s[36:39], s56 offen sc1
    s_lshl_b32 s56, s85, 6
    buffer_store_dwordx4 v[104:107], v28, s[36:39], s56 offen sc1
    s_lshl_b32 s56, s86, 6
    buffer_store_dwordx4 v[108:111], v28, s[36:39], s56 offen sc1
    s_lshl_b32 s56, s87, 6
    buffer_store_dwordx4 v[112:115], v28, s[36:39], s56 offen sc1
    s_mov_b64 exec, -1
    s_cmp_lg_u32 s52, 4
    s_cbranch_scc1 L_wa_37
    s_add_u32 s56, s55, 3
    v_lshlrev_b32 v252, 7, v0
    s_mov_b32 s57, 0x200000
L_poll_38:
    buffer_load_dwordx4 v[248:251], v252, s[36:39], 0 offen sc1
    s_sub_u32 s57, s57, 1
    s_cmp_eq_u32 s57, 0
    s_cbranch_scc1 L_pollx_39
    s_waitcnt vmcnt(0)
    v_subrev_u32 v248, s56, v248
    v_subrev_u32 v249, s56, v249
    v_subrev_u32 v250, s56, v250
    v_subrev_u32 v251, s56, v251
    v_max_u32 v248, v248, v249
    v_max3_u32 v248, v248, v250, v251
    v_cmp_le_u32 vcc, 16, v248
    s_cbranch_vccnz L_poll_38
L_pollx_39:
    s_waitcnt vmcnt(0)
L_wa_37:
    s_barrier
    s_mov_b32 s64, 0
    s_add_u32 m0, s64, s62
    s_nop 0
    buffer_load_dwordx4 v200, s[36:39], s88 offen sc1 lds
    s_add_u32 m0, m0, 1024
    s_nop 0
    buffer_load_dwordx4 v201, s[36:39], s88 offen sc1 lds
    s_add_u32 m0, m0, 1024
    s_nop 0
    buffer_load_dwordx4 v202, s[36:39], s88 offen sc1 lds
    s_add_u32 m0, m0, 1024
    s_nop 0
    buffer_load_dwordx4 v203, s[36:39], s88 offen sc1 lds
    s_mov_b32 s64, 45056
    s_add_u32 m0, s64, s62
    s_nop 0
    buffer_load_dwordx4 v200, s[36:39], s66 offen sc1 lds
    s_add_u32 m0, m0, 1024
    s_nop 0
    buffer_load_dwordx4 v201, s[36:39], s66 offen sc1 lds
    s_add_u32 m0, m0, 1024
    s_nop 0
    buffer_load_dwordx4 v202, s[36:39], s66 offen sc1 lds
    s_add_u32 m0, m0, 1024
    s_nop 0
    buffer_load_dwordx4 v203, s[36:39], s66 offen sc1 lds
    s_waitcnt vmcnt(4) lgkmcnt(0)
    s_barrier
    s_mov_b32 s67, 0
    s_mov_b32 s64, 90112
    s_lshl_b32 s89, s2, 15
    s_lshl_b32 s56, s58, 13
    s_add_u32 s89, s89, s56
    s_add_u32 s89, s89, 29360128
    v_lshlrev_b32 v128, 4, v0
    v_mov_b32 v132, -1
    v_mov_b32 v133, -1
    v_mov_b32 v134, -1
    v_mov_b32 v135, -1
L_g1l_40:
    s_cmp_eq_u32 s67, 12
    s_cbranch_scc0 L_g1a_43
    v_and_b32 v20, 15, v0
    v_bfe_u32 v21, v0, 4, 1
    v_cmp_eq_u32 vcc, 0, v21
    v_mov_b32 v22, s60
    v_mov_b32 v23, s61
    v_cndmask_b32 v24, v20, v22, vcc
    v_cndmask_b32 v25, v23, v20, vcc
    v_lshrrev_b32 v40, 3, v24
    v_lshrrev_b32 v26, 2, v25
    v_lshl_add_u32 v40, v26, 1, v40
    v_and_b32 v26, 7, v24
    v_lshl_add_u32 v40, v26, 3, v40
    v_and_b32 v26, 3, v25
    v_lshl_add_u32 v40, v26, 6, v40
    v_and_b32 v26, 7, v40
    v_lshlrev_b32 v26, 10, v26
    v_lshrrev_b32 v27, 5, v40
    v_lshl_add_u32 v26, v27, 7, v26
    v_bfe_u32 v40, v40, 3, 2
    v_lshl_add_u32 v40, v40, 2, v26
    buffer_load_dword v41, v40, s[36:39], 0 offen sc1
L_g1a_43:
    s_cmp_ge_u32 s67, 14
    s_cbranch_scc1 L_g1lw_41
    s_add_u32 s68, s68, 1
    s_and_b32 s68, s68, 15
    s_mul_i32 s65, s68, 458752
    s_lshl_b32 s66, s68, 14
    s_add_u32 m0, s64, s63
    s_nop 0
    buffer_load_dwordx4 v204, s[44:47], s65 offen lds
    s_add_u32 m0, m0, 1024
    s_nop 0
    buffer_load_dwordx4 v205, s[44:47], s65 offen lds
    s_add_u32 m0, m0, 1024
    s_nop 0
    buffer_load_dwordx4 v206, s[44:47], s65 offen lds
    s_add_u32 m0, m0, 1024
    s_nop 0
    buffer_load_dwordx4 v207, s[44:47], s65 offen lds
    s_add_u32 m0, m0, 1024
    s_nop 0
    buffer_load_dwordx4 v208, s[44:47], s65 offen lds
    s_add_u32 m0, m0, 1024
    s_nop 0
    buffer_load_dwordx4 v209, s[44:47], s65 offen lds
    s_add_u32 m0, m0, 1024
    s_nop 0
    buffer_load_dwordx4 v210, s[44:47], s65 offen lds
    s_add_u32 m0, s64, s62
    s_nop 0
    buffer_load_dwordx4 v200, s[36:39], s66 offen sc1 lds
    s_add_u32 m0, m0, 1024
    s_nop 0
    buffer_load_dwordx4 v201, s[36:39], s66 offen sc1 lds
    s_add_u32 m0, m0, 1024
    s_nop 0
    buffer_load_dwordx4 v202, s[36:39], s66 offen sc1 lds
    s_add_u32 m0, m0, 1024
    s_nop 0
    buffer_load_dwordx4 v203, s[36:39], s66 offen sc1 lds
    s_add_u32 s64, s64, 45056
    s_cmp_eq_u32 s64, 135168
    s_cselect_b32 s64, 0, s64
    s_cmp_eq_u32 s67, 13
    s_cbranch_scc0 L_g1a_44
    s_add_u32 s56, s55, 4
    v_subrev_u32 v41, s56, v41
    v_cmp_le_u32 vcc, 16, v41
    s_cbranch_vccz L_g1p_45
    s_add_u32 s56, s55, 4
    s_mov_b32 s57, 0x200000
L_pa_46:
    buffer_load_dword v41, v40, s[36:39], 0 offen sc1
    s_sub_u32 s57, s57, 1
    s_cmp_eq_u32 s57, 0
    s_cbranch_scc1 L_pax_47
    s_waitcnt vmcnt(0)
    v_subrev_u32 v41, s56, v41
    v_cmp_le_u32 vcc, 16, v41
    s_cbranch_vccnz L_pa_46
L_pax_47:
    s_waitcnt vmcnt(0)
L_g1p_45:
    v_and_b32 v20, 31, v0
    s_lshl_b32 s56, s58, 5
    v_add_u32 v42, s56, v20
    v_lshrrev_b32 v21, 5, v0
    v_lshlrev_b32 v21, 13, v21
    v_lshl_add_u32 v21, v42, 3, v21
    s_lshl_b32 s56, s60, 14
    s_add_u32 s56, s56, 131072
    v_add_u32 v21, s56, v21
    buffer_load_dwordx2 v[44:45], v21, s[36:39], 0 offen offset:0 sc1
    buffer_load_dwordx2 v[46:47], v21, s[36:39], 0 offen offset:1024 sc1
    buffer_load_dwordx2 v[48:49], v21, s[36:39], 0 offen offset:2048 sc1
    buffer_load_dwordx2 v[50:51], v21, s[36:39], 0 offen offset:3072 sc1
    v_add_u32 v21, 4096, v21
    buffer_load_dwordx2 v[52:53], v21, s[36:39], 0 offen offset:0 sc1
    buffer_load_dwordx2 v[54:55], v21, s[36:39], 0 offen offset:1024 sc1
    buffer_load_dwordx2 v[56:57], v21, s[36:39], 0 offen offset:2048 sc1
    buffer_load_dwordx2 v[58:59], v21, s[36:39], 0 offen offset:3072 sc1
    v_and_b32 v20, 15, v0
    v_min_u32 v20, 13, v20
    s_mul_i32 s56, s58, 14
    v_add_u32 v43, s56, v20
    v_lshrrev_b32 v21, 4, v0
    v_lshlrev_b32 v21, 12, v21
    v_lshl_add_u32 v21, v43, 4, v21
    s_lshl_b32 s56, s61, 14
    s_add_u32 s56, s56, 393216
    v_add_u32 v21, s56, v21
    buffer_load_dwordx4 v[60:63], v21, s[36:39], 0 offen offset:0 sc1
    buffer_load_dwordx4 v[64:67], v21, s[36:39], 0 offen offset:1024 sc1
    buffer_load_dwordx4 v[68:71], v21, s[36:39], 0 offen offset:2048 sc1
    buffer_load_dwordx4 v[72:75], v21, s[36:39], 0 offen offset:3072 sc1
    s_waitcnt vmcnt(23)
    s_branch L_g1lb_42
L_g1a_44:
    s_cmp_eq_u32 s67, 0
    s_cbranch_scc0 L_g1a_48
    buffer_store_dwordx4 v[132:135], v128, s[36:39], s89 offen sc1
    s_add_u32 s89, s89, 1024
    s_waitcnt vmcnt(12)
    s_branch L_g1lb_42
L_g1a_48:
    s_cmp_lt_u32 s67, 8
    s_cbranch_scc0 L_g1s8_49
    buffer_store_dwordx4 v[132:135], v128, s[36:39], s89 offen sc1
    s_add_u32 s89, s89, 1024
    s_waitcnt vmcnt(13)
    s_cmp_eq_u32 s67, 3
    s_cbranch_scc0 L_g1a_50
    s_cmp_eq_u32 s52, 4
    s_cbranch_scc0 L_g1pub_51
    s_add_u32 s56, s55, 4
    v_mov_b32 v254, s56
    s_lshl_b32 s57, s53, 10
    s_lshr_b32 s56, s54, 2
    s_lshl_b32 s56, s56, 7
    s_add_u32 s57, s57, s56
    s_and_b32 s56, s54, 3
    s_lshl_b32 s56, s56, 2
    s_add_u32 s57, s57, s56
    v_mov_b32 v255, s57
    s_mov_b64 exec, 1
    buffer_store_dword v254, v255, s[36:39], 0 offen sc1
    s_mov_b64 exec, -1
L_g1pub_51:
L_g1a_50:
    s_branch L_g1lb_42
L_g1s8_49:
    s_waitcnt vmcnt(11)
    s_branch L_g1lb_42
L_g1lw_41:
    s_cmp_eq_u32 s67, 14
    s_cbranch_scc0 L_g1l15_52
    s_waitcnt vmcnt(12)
    s_mov_b32 s48, s26
    s_mov_b32 s49, s27
    s_mov_b32 s50, 7340032
    s_mov_b32 s51, 0x20000
    s_lshl_b32 s56, s2, 2
    s_add_u32 s56, s56, s58
    s_mul_i32 s56, s56, 56*128
    v_min_u32 v247, 55, v0
    v_lshlrev_b32 v247, 7, v247
    v_add_u32 v247, s56, v247
    buffer_load_dword v246, v247, s[48:51], 0 offen
    s_branch L_g1lb_42
L_g1l15_52:
    s_waitcnt vmcnt(1)
    v_pk_add_f32 v[44:45], v[44:45], v[46:47]
    v_pk_add_f32 v[44:45], v[44:45], v[48:49]
    v_pk_add_f32 v[44:45], v[44:45], v[50:51]
    v_pk_add_f32 v[44:45], v[44:45], v[52:53]
    v_pk_add_f32 v[44:45], v[44:45], v[54:55]
    v_pk_add_f32 v[44:45], v[44:45], v[56:57]
    v_pk_add_f32 v[44:45], v[44:45], v[58:59]
    v_mov_b32 v46, v44
    v_mov_b32 v47, v45
    s_nop 0
    v_permlane32_swap_b32 v46, v44
    v_permlane32_swap_b32 v47, v45
    v_add_f32 v44, v44, v46
    v_add_f32 v45, v45, v47
    v_mul_f32 v44, 0x3a800000, v44
    v_mul_f32 v45, 0x3a800000, v45
    v_fma_f32 v45, -v44, v44, v45
    v_max_f32 v45, 0, v45
    v_cvt_pk_bf16_f32 v46, v44, v44
    v_and_b32 v46, 0xffff0000, v46
    v_cvt_pk_bf16_f32 v47, v45, v45
    v_and_b32 v47, 0xffff0000, v47
    v_add_f32 v47, 0x3727c5ac, v47
    v_cvt_pk_bf16_f32 v47, v47, v47
    v_and_b32 v47, 0xffff0000, v47
    v_sqrt_f32 v47, v47
    s_nop 0
    v_cvt_pk_bf16_f32 v47, v47, v47
    v_and_b32 v47, 0xffff0000, v47
    v_rcp_f32 v48, v47
    v_sub_f32 v49, v44, v46
    v_mul_f32 v49, v49, v48
    v_cvt_pk_bf16_f32 v49, v49, v49
    v_and_b32 v49, 0xffff0000, v49
    v_mul_f32 v50, v45, v48
    v_mul_f32 v50, v50, v48
    v_cvt_pk_bf16_f32 v50, v50, v50
    v_and_b32 v50, 0xffff0000, v50
    v_add_f32 v50, 0x3727c5ac, v50
    v_cvt_pk_bf16_f32 v50, v50, v50
    v_and_b32 v50, 0xffff0000, v50
    v_sqrt_f32 v50, v50
    s_nop 0
    v_cvt_pk_bf16_f32 v50, v50, v50
    v_and_b32 v50, 0xffff0000, v50
    v_rcp_f32 v50, v50
    s_nop 0
    v_mul_f32 v52, v48, v50
    v_fma_f32 v51, v49, v47, v46
    v_mul_f32 v53, v52, v51
    v_lshlrev_b32 v20, 3, v42
    v_add_u32 v20, 135168, v20
    s_mov_b32 exec_hi, 0
    ds_write_b64 v20, v[52:53]
    s_mov_b64 exec, -1
    s_waitcnt lgkmcnt(0)
L_g1lb_42:
    s_barrier
    s_add_u32 s67, s67, 1
    s_cmp_lt_u32 s67, 16
    s_cbranch_scc1 L_g1l_40
    v_pk_add_f32 v[60:61], v[60:61], v[64:65]
    v_pk_add_f32 v[62:63], v[62:63], v[66:67]
    v_pk_add_f32 v[60:61], v[60:61], v[68:69]
    v_pk_add_f32 v[62:63], v[62:63], v[70:71]
    v_pk_add_f32 v[60:61], v[60:61], v[72:73]
    v_pk_add_f32 v[62:63], v[62:63], v[74:75]
    v_mov_b32 v64, v60
    v_mov_b32 v65, v61
    v_mov_b32 v66, v62
    v_mov_b32 v67, v63
    v_permlane16_swap_b32 v64, v60
    v_permlane16_swap_b32 v65, v61
    v_permlane16_swap_b32 v66, v62
    v_permlane16_swap_b32 v67, v63
    v_add_f32 v60, v60, v64
    v_add_f32 v61, v61, v65
    v_add_f32 v62, v62, v66
    v_add_f32 v63, v63, v67
    v_mov_b32 v64, v60
    v_mov_b32 v65, v61
    v_mov_b32 v66, v62
    v_mov_b32 v67, v63
    v_permlane32_swap_b32 v64, v60
    v_permlane32_swap_b32 v65, v61
    v_permlane32_swap_b32 v66, v62
    v_permlane32_swap_b32 v67, v63
    v_add_f32 v60, v60, v64
    v_add_f32 v61, v61, v65
    v_add_f32 v62, v62, v66
    v_add_f32 v63, v63, v67
    v_lshlrev_b32 v68, 16, v240
    v_and_b32 v69, 0xffff0000, v240
    v_lshlrev_b32 v70, 16, v241
    v_and_b32 v71, 0xffff0000, v241
    v_lshlrev_b32 v20, 4, v43
    v_add_u32 v20, 136192, v20
    s_mov_b64 exec, 0x3fff
    ds_write_b128 v20, v[60:63]
    ds_write_b128 v20, v[68:71] offset:1024
    s_mov_b64 exec, -1
    s_waitcnt lgkmcnt(0)
    s_barrier
    s_branch L_g1end_36
L_g1comp_35:
    s_lshr_b32 s58, s52, 1
    s_and_b32 s59, s52, 1
    v_lshrrev_b32 v13, 4, v0
    v_and_b32 v14, 15, v0
    v_lshrrev_b32 v15, 2, v14
    v_and_b32 v16, 3, v14
    v_lshl_add_u32 v17, v13, 3, v15
    v_and_b32 v18, 1, v13
    v_mul_u32_u24 v19, 448, v17
    v_lshl_add_u32 v19, v16, 3, v19
    s_mul_i32 s57, s58, 224
    s_add_u32 s57, s57, 16384
    v_add_u32 v19, s57, v19
    v_lshlrev_b32 v20, 5, v18
    v_add_u32 v21, v19, v20
    v_sub_u32 v22, v19, v20
    s_cmp_eq_u32 s58, 0
    s_cselect_b64 vcc, -1, 0
    v_cndmask_b32 v2, v22, v21, vcc
    v_cndmask_b32 v3, v21, v22, vcc
    v_lshl_or_b32 v20, v18, 2, v15
    v_lshlrev_b32 v21, 8, v17
    v_lshl_add_u32 v21, v16, 3, v21
    s_lshl_b32 s57, s59, 2
    s_add_u32 s56, s57, 0
    v_xor_b32 v22, s56, v20
    v_lshl_add_u32 v4, v22, 5, v21
    s_add_u32 s56, s57, 1
    v_xor_b32 v22, s56, v20
    v_lshl_add_u32 v5, v22, 5, v21
    s_add_u32 s56, s57, 2
    v_xor_b32 v22, s56, v20
    v_lshl_add_u32 v6, v22, 5, v21
    s_add_u32 s56, s57, 3
    v_xor_b32 v22, s56, v20
    v_lshl_add_u32 v7, v22, 5, v21
    v_mov_b32 v224, 0x3f803f80
    v_mov_b32 v225, 0x3f803f80
    v_mov_b32 v226, 0x3f803f80
    v_mov_b32 v227, 0x3f803f80
    s_barrier
    s_cmp_lg_u32 s52, 4
    s_cbranch_scc1 L_wa_53
    s_add_u32 s56, s55, 3
    v_lshlrev_b32 v252, 7, v0
    s_mov_b32 s57, 0x200000
L_poll_54:
    buffer_load_dwordx4 v[248:251], v252, s[36:39], 0 offen sc1
    s_sub_u32 s57, s57, 1
    s_cmp_eq_u32 s57, 0
    s_cbranch_scc1 L_pollx_55
    s_waitcnt vmcnt(0)
    v_subrev_u32 v248, s56, v248
    v_subrev_u32 v249, s56, v249
    v_subrev_u32 v250, s56, v250
    v_subrev_u32 v251, s56, v251
    v_max_u32 v248, v248, v249
    v_max3_u32 v248, v248, v250, v251
    v_cmp_le_u32 vcc, 16, v248
    s_cbranch_vccnz L_poll_54
L_pollx_55:
    s_waitcnt vmcnt(0)
L_wa_53:
    s_barrier
    s_barrier
    ds_read_b64_tr_b16 v[36:37], v4 offset:0
    ds_read_b64_tr_b16 v[38:39], v4 offset:1024
    ds_read_b64_tr_b16 v[40:41], v5 offset:0
    ds_read_b64_tr_b16 v[42:43], v5 offset:1024
    ds_read_b64_tr_b16 v[44:45], v6 offset:0
    ds_read_b64_tr_b16 v[46:47], v6 offset:1024
    ds_read_b64_tr_b16 v[48:49], v7 offset:0
    ds_read_b64_tr_b16 v[50:51], v7 offset:1024
    ds_read_b64_tr_b16 v[8:9], v2 offset:0
    ds_read_b64_tr_b16 v[10:11], v2 offset:1792
    ds_read_b64_tr_b16 v[12:13], v3 offset:32
    ds_read_b64_tr_b16 v[14:15], v3 offset:1824
    ds_read_b64_tr_b16 v[16:17], v2 offset:64
    ds_read_b64_tr_b16 v[18:19], v2 offset:1856
    ds_read_b64_tr_b16 v[20:21], v3 offset:96
    ds_read_b64_tr_b16 v[22:23], v3 offset:1888
    ds_read_b64_tr_b16 v[24:25], v2 offset:128
    ds_read_b64_tr_b16 v[26:27], v2 offset:1920
    ds_read_b64_tr_b16 v[28:29], v3 offset:160
    ds_read_b64_tr_b16 v[30:31], v3 offset:1952
    ds_read_b64_tr_b16 v[32:33], v2 offset:192
    ds_read_b64_tr_b16 v[34:35], v2 offset:1984
    s_waitcnt lgkmcnt(0)
    v_mfma_f32_16x16x32_bf16 v[96:99], v[8:11], v[36:39], 0
    ds_read_b64_tr_b16 v[80:81], v4 offset:8192
    v_mfma_f32_16x16x32_bf16 v[100:103], v[8:11], v[40:43], 0
    ds_read_b64_tr_b16 v[82:83], v4 offset:9216
    v_mfma_f32_16x16x32_bf16 v[104:107], v[8:11], v[44:47], 0
    ds_read_b64_tr_b16 v[84:85], v5 offset:8192
    v_mfma_f32_16x16x32_bf16 v[108:111], v[8:11], v[48:51], 0
    ds_read_b64_tr_b16 v[86:87], v5 offset:9216
    v_mfma_f32_16x16x32_bf16 v[112:115], v[12:15], v[36:39], 0
    ds_read_b64_tr_b16 v[88:89], v6 offset:8192
    v_mfma_f32_16x16x32_bf16 v[116:119], v[12:15], v[40:43], 0
    ds_read_b64_tr_b16 v[90:91], v6 offset:9216
    v_mfma_f32_16x16x32_bf16 v[120:123], v[12:15], v[44:47], 0
    ds_read_b64_tr_b16 v[92:93], v7 offset:8192
    v_mfma_f32_16x16x32_bf16 v[124:127], v[12:15], v[48:51], 0
    ds_read_b64_tr_b16 v[94:95], v7 offset:9216
    v_mfma_f32_16x16x32_bf16 v[128:131], v[16:19], v[36:39], 0
    ds_read_b64_tr_b16 v[52:53], v2 offset:14336
    v_mfma_f32_16x16x32_bf16 v[132:135], v[16:19], v[40:43], 0
    ds_read_b64_tr_b16 v[54:55], v2 offset:16128
    v_mfma_f32_16x16x32_bf16 v[136:139], v[16:19], v[44:47], 0
    ds_read_b64_tr_b16 v[56:57], v3 offset:14368
    v_mfma_f32_16x16x32_bf16 v[140:143], v[16:19], v[48:51], 0
    ds_read_b64_tr_b16 v[58:59], v3 offset:16160
    v_mfma_f32_16x16x32_bf16 v[144:147], v[20:23], v[36:39], 0
    ds_read_b64_tr_b16 v[60:61], v2 offset:14400
    v_mfma_f32_16x16x32_bf16 v[148:151], v[20:23], v[40:43], 0
    ds_read_b64_tr_b16 v[62:63], v2 offset:16192
    v_mfma_f32_16x16x32_bf16 v[152:155], v[20:23], v[44:47], 0
    ds_read_b64_tr_b16 v[64:65], v3 offset:14432
    v_mfma_f32_16x16x32_bf16 v[156:159], v[20:23], v[48:51], 0
    ds_read_b64_tr_b16 v[66:67], v3 offset:16224
    v_mfma_f32_16x16x32_bf16 v[160:163], v[24:27], v[36:39], 0
    ds_read_b64_tr_b16 v[68:69], v2 offset:14464
    v_mfma_f32_16x16x32_bf16 v[164:167], v[24:27], v[40:43], 0
    ds_read_b64_tr_b16 v[70:71], v2 offset:16256
    v_mfma_f32_16x16x32_bf16 v[168:171], v[24:27], v[44:47], 0
    ds_read_b64_tr_b16 v[72:73], v3 offset:14496
    v_mfma_f32_16x16x32_bf16 v[172:175], v[24:27], v[48:51], 0
    ds_read_b64_tr_b16 v[74:75], v3 offset:16288
    v_mfma_f32_16x16x32_bf16 v[176:179], v[28:31], v[36:39], 0
    ds_read_b64_tr_b16 v[76:77], v2 offset:14528
    v_mfma_f32_16x16x32_bf16 v[180:183], v[28:31], v[40:43], 0
    ds_read_b64_tr_b16 v[78:79], v2 offset:16320
    v_mfma_f32_16x16x32_bf16 v[184:187], v[28:31], v[44:47], 0
    v_add_u32 v2, 0xb000, v2
    v_mfma_f32_16x16x32_bf16 v[188:191], v[28:31], v[48:51], 0
    v_add_u32 v3, 0xb000, v3
    v_mfma_f32_16x16x32_bf16 v[192:195], v[32:35], v[36:39], 0
    v_add_u32 v4, 0xb000, v4
    v_mfma_f32_16x16x32_bf16 v[196:199], v[32:35], v[40:43], 0
    v_add_u32 v5, 0xb000, v5
    v_mfma_f32_16x16x32_bf16 v[200:203], v[32:35], v[44:47], 0
    v_add_u32 v6, 0xb000, v6
    v_mfma_f32_16x16x32_bf16 v[204:207], v[32:35], v[48:51], 0
    v_add_u32 v7, 0xb000, v7
    s_cmp_eq_u32 s58, 0
    s_cbranch_scc0 L_g1t_56
    v_mfma_f32_16x16x32_bf16 v[208:211], v[224:227], v[36:39], 0
    v_mfma_f32_16x16x32_bf16 v[216:219], v[36:39], v[36:39], 0
    v_mfma_f32_16x16x32_bf16 v[212:215], v[224:227], v[40:43], 0
    v_mfma_f32_16x16x32_bf16 v[220:223], v[40:43], v[40:43], 0
    s_branch L_g1t2_57
L_g1t_56:
    s_nop 1
    v_mfma_f32_16x16x32_bf16 v[208:211], v[224:227], v[44:47], 0
    v_mfma_f32_16x16x32_bf16 v[216:219], v[44:47], v[44:47], 0
    v_mfma_f32_16x16x32_bf16 v[212:215], v[224:227], v[48:51], 0
    v_mfma_f32_16x16x32_bf16 v[220:223], v[48:51], v[48:51], 0
L_g1t2_57:
    s_waitcnt lgkmcnt(0)
    s_cmp_eq_u32 s58, 0
    s_cbranch_scc0 L_g1t_58
    v_mfma_f32_16x16x32_bf16 v[208:211], v[224:227], v[80:83], v[208:211]
    v_mfma_f32_16x16x32_bf16 v[216:219], v[80:83], v[80:83], v[216:219]
    v_mfma_f32_16x16x32_bf16 v[212:215], v[224:227], v[84:87], v[212:215]
    v_mfma_f32_16x16x32_bf16 v[220:223], v[84:87], v[84:87], v[220:223]
    s_branch L_g1t2_59
L_g1t_58:
    v_mfma_f32_16x16x32_bf16 v[208:211], v[224:227], v[88:91], v[208:211]
    v_mfma_f32_16x16x32_bf16 v[216:219], v[88:91], v[88:91], v[216:219]
    v_mfma_f32_16x16x32_bf16 v[212:215], v[224:227], v[92:95], v[212:215]
    v_mfma_f32_16x16x32_bf16 v[220:223], v[92:95], v[92:95], v[220:223]
L_g1t2_59:
    s_lshl_b32 s56, s60, 4
    s_add_u32 s56, s56, s61
    s_lshl_b32 s56, s56, 10
    s_add_u32 s56, s56, 131072
    s_lshl_b32 s57, s59, 9
    s_add_u32 s56, s56, s57
    s_lshl_b32 s57, s58, 8
    s_add_u32 s56, s56, s57
    v_and_b32 v228, 15, v0
    v_lshl_add_u32 v228, v228, 3, s56
    s_mov_b32 s80, 0x22222222
    s_mov_b32 s81, 0x22222222
    s_mov_b32 s82, 0x44444444
    s_mov_b32 s83, 0x44444444
    s_mov_b32 vcc_lo, 0x88888888
    s_mov_b32 vcc_hi, 0x88888888
    v_mov_b32 v230, v208
    v_cndmask_b32 v231, v216, v217, s[80:81]
    v_cndmask_b32 v231, v231, v218, s[82:83]
    v_cndmask_b32 v231, v231, v219, vcc
    v_mov_b32 v232, v212
    v_cndmask_b32 v233, v220, v221, s[80:81]
    v_cndmask_b32 v233, v233, v222, s[82:83]
    v_cndmask_b32 v233, v233, v223, vcc
    s_mov_b32 exec_lo, 0x00f0000f
    s_mov_b32 exec_hi, 0xf0000f00
    buffer_store_dwordx2 v[230:231], v228, s[36:39], 0 offen offset:0 sc1
    buffer_store_dwordx2 v[232:233], v228, s[36:39], 0 offen offset:128 sc1
    s_mov_b64 exec, -1
    s_barrier
    s_mov_b32 s67, 0
L_g1c_60:
    v_mfma_f32_16x16x32_bf16 v[96:99], v[52:55], v[80:83], v[96:99]
    ds_read_b64_tr_b16 v[36:37], v4 offset:0
    v_mfma_f32_16x16x32_bf16 v[100:103], v[52:55], v[84:87], v[100:103]
    ds_read_b64_tr_b16 v[38:39], v4 offset:1024
    v_mfma_f32_16x16x32_bf16 v[104:107], v[52:55], v[88:91], v[104:107]
    ds_read_b64_tr_b16 v[40:41], v5 offset:0
    v_mfma_f32_16x16x32_bf16 v[108:111], v[52:55], v[92:95], v[108:111]
    ds_read_b64_tr_b16 v[42:43], v5 offset:1024
    v_mfma_f32_16x16x32_bf16 v[112:115], v[56:59], v[80:83], v[112:115]
    ds_read_b64_tr_b16 v[44:45], v6 offset:0
    v_mfma_f32_16x16x32_bf16 v[116:119], v[56:59], v[84:87], v[116:119]
    ds_read_b64_tr_b16 v[46:47], v6 offset:1024
    v_mfma_f32_16x16x32_bf16 v[120:123], v[56:59], v[88:91], v[120:123]
    ds_read_b64_tr_b16 v[48:49], v7 offset:0
    v_mfma_f32_16x16x32_bf16 v[124:127], v[56:59], v[92:95], v[124:127]
    ds_read_b64_tr_b16 v[50:51], v7 offset:1024
    v_mfma_f32_16x16x32_bf16 v[128:131], v[60:63], v[80:83], v[128:131]
    ds_read_b64_tr_b16 v[8:9], v2 offset:0
    v_mfma_f32_16x16x32_bf16 v[132:135], v[60:63], v[84:87], v[132:135]
    ds_read_b64_tr_b16 v[10:11], v2 offset:1792
    v_mfma_f32_16x16x32_bf16 v[136:139], v[60:63], v[88:91], v[136:139]
    ds_read_b64_tr_b16 v[12:13], v3 offset:32
    v_mfma_f32_16x16x32_bf16 v[140:143], v[60:63], v[92:95], v[140:143]
    ds_read_b64_tr_b16 v[14:15], v3 offset:1824
    v_mfma_f32_16x16x32_bf16 v[144:147], v[64:67], v[80:83], v[144:147]
    ds_read_b64_tr_b16 v[16:17], v2 offset:64
    v_mfma_f32_16x16x32_bf16 v[148:151], v[64:67], v[84:87], v[148:151]
    ds_read_b64_tr_b16 v[18:19], v2 offset:1856
    v_mfma_f32_16x16x32_bf16 v[152:155], v[64:67], v[88:91], v[152:155]
    ds_read_b64_tr_b16 v[20:21], v3 offset:96
    v_mfma_f32_16x16x32_bf16 v[156:159], v[64:67], v[92:95], v[156:159]
    ds_read_b64_tr_b16 v[22:23], v3 offset:1888
    v_mfma_f32_16x16x32_bf16 v[160:163], v[68:71], v[80:83], v[160:163]
    ds_read_b64_tr_b16 v[24:25], v2 offset:128
    v_mfma_f32_16x16x32_bf16 v[164:167], v[68:71], v[84:87], v[164:167]
    ds_read_b64_tr_b16 v[26:27], v2 offset:1920
    v_mfma_f32_16x16x32_bf16 v[168:171], v[68:71], v[88:91], v[168:171]
    ds_read_b64_tr_b16 v[28:29], v3 offset:160
    v_mfma_f32_16x16x32_bf16 v[172:175], v[68:71], v[92:95], v[172:175]
    ds_read_b64_tr_b16 v[30:31], v3 offset:1952
    v_mfma_f32_16x16x32_bf16 v[176:179], v[72:75], v[80:83], v[176:179]
    ds_read_b64_tr_b16 v[32:33], v2 offset:192
    v_mfma_f32_16x16x32_bf16 v[180:183], v[72:75], v[84:87], v[180:183]
    ds_read_b64_tr_b16 v[34:35], v2 offset:1984
    v_mfma_f32_16x16x32_bf16 v[184:187], v[72:75], v[88:91], v[184:187]
    v_mfma_f32_16x16x32_bf16 v[188:191], v[72:75], v[92:95], v[188:191]
    v_mfma_f32_16x16x32_bf16 v[192:195], v[76:79], v[80:83], v[192:195]
    v_mfma_f32_16x16x32_bf16 v[196:199], v[76:79], v[84:87], v[196:199]
    v_mfma_f32_16x16x32_bf16 v[200:203], v[76:79], v[88:91], v[200:203]
    v_mfma_f32_16x16x32_bf16 v[204:207], v[76:79], v[92:95], v[204:207]
    s_waitcnt lgkmcnt(4)
    v_mfma_f32_16x16x32_bf16 v[96:99], v[8:11], v[36:39], v[96:99]
    ds_read_b64_tr_b16 v[80:81], v4 offset:8192
    v_mfma_f32_16x16x32_bf16 v[100:103], v[8:11], v[40:43], v[100:103]
    ds_read_b64_tr_b16 v[82:83], v4 offset:9216
    v_mfma_f32_16x16x32_bf16 v[104:107], v[8:11], v[44:47], v[104:107]
    ds_read_b64_tr_b16 v[84:85], v5 offset:8192
    v_mfma_f32_16x16x32_bf16 v[108:111], v[8:11], v[48:51], v[108:111]
    ds_read_b64_tr_b16 v[86:87], v5 offset:9216
    v_mfma_f32_16x16x32_bf16 v[112:115], v[12:15], v[36:39], v[112:115]
    ds_read_b64_tr_b16 v[88:89], v6 offset:8192
    v_mfma_f32_16x16x32_bf16 v[116:119], v[12:15], v[40:43], v[116:119]
    ds_read_b64_tr_b16 v[90:91], v6 offset:9216
    v_mfma_f32_16x16x32_bf16 v[120:123], v[12:15], v[44:47], v[120:123]
    ds_read_b64_tr_b16 v[92:93], v7 offset:8192
    v_mfma_f32_16x16x32_bf16 v[124:127], v[12:15], v[48:51], v[124:127]
    ds_read_b64_tr_b16 v[94:95], v7 offset:9216
    v_mfma_f32_16x16x32_bf16 v[128:131], v[16:19], v[36:39], v[128:131]
    ds_read_b64_tr_b16 v[52:53], v2 offset:14336
    v_mfma_f32_16x16x32_bf16 v[132:135], v[16:19], v[40:43], v[132:135]
    ds_read_b64_tr_b16 v[54:55], v2 offset:16128
    v_mfma_f32_16x16x32_bf16 v[136:139], v[16:19], v[44:47], v[136:139]
    ds_read_b64_tr_b16 v[56:57], v3 offset:14368
    v_mfma_f32_16x16x32_bf16 v[140:143], v[16:19], v[48:51], v[140:143]
    ds_read_b64_tr_b16 v[58:59], v3 offset:16160
    v_mfma_f32_16x16x32_bf16 v[144:147], v[20:23], v[36:39], v[144:147]
    ds_read_b64_tr_b16 v[60:61], v2 offset:14400
    v_mfma_f32_16x16x32_bf16 v[148:151], v[20:23], v[40:43], v[148:151]
    ds_read_b64_tr_b16 v[62:63], v2 offset:16192
    v_mfma_f32_16x16x32_bf16 v[152:155], v[20:23], v[44:47], v[152:155]
    ds_read_b64_tr_b16 v[64:65], v3 offset:14432
    v_mfma_f32_16x16x32_bf16 v[156:159], v[20:23], v[48:51], v[156:159]
    ds_read_b64_tr_b16 v[66:67], v3 offset:16224
    v_mfma_f32_16x16x32_bf16 v[160:163], v[24:27], v[36:39], v[160:163]
    ds_read_b64_tr_b16 v[68:69], v2 offset:14464
    v_mfma_f32_16x16x32_bf16 v[164:167], v[24:27], v[40:43], v[164:167]
    ds_read_b64_tr_b16 v[70:71], v2 offset:16256
    v_mfma_f32_16x16x32_bf16 v[168:171], v[24:27], v[44:47], v[168:171]
    ds_read_b64_tr_b16 v[72:73], v3 offset:14496
    v_mfma_f32_16x16x32_bf16 v[172:175], v[24:27], v[48:51], v[172:175]
    ds_read_b64_tr_b16 v[74:75], v3 offset:16288
    s_waitcnt lgkmcnt(15)
    v_mfma_f32_16x16x32_bf16 v[176:179], v[28:31], v[36:39], v[176:179]
    ds_read_b64_tr_b16 v[76:77], v2 offset:14528
    v_mfma_f32_16x16x32_bf16 v[180:183], v[28:31], v[40:43], v[180:183]
    ds_read_b64_tr_b16 v[78:79], v2 offset:16320
    v_mfma_f32_16x16x32_bf16 v[184:187], v[28:31], v[44:47], v[184:187]
    v_add_u32 v2, 0xb000, v2
    v_mfma_f32_16x16x32_bf16 v[188:191], v[28:31], v[48:51], v[188:191]
    v_add_u32 v3, 0xb000, v3
    v_mfma_f32_16x16x32_bf16 v[192:195], v[32:35], v[36:39], v[192:195]
    v_add_u32 v4, 0xb000, v4
    v_mfma_f32_16x16x32_bf16 v[196:199], v[32:35], v[40:43], v[196:199]
    v_add_u32 v5, 0xb000, v5
    v_mfma_f32_16x16x32_bf16 v[200:203], v[32:35], v[44:47], v[200:203]
    v_add_u32 v6, 0xb000, v6
    v_mfma_f32_16x16x32_bf16 v[204:207], v[32:35], v[48:51], v[204:207]
    v_add_u32 v7, 0xb000, v7
    s_waitcnt lgkmcnt(0)
    s_barrier
    v_mfma_f32_16x16x32_bf16 v[96:99], v[52:55], v[80:83], v[96:99]
    ds_read_b64_tr_b16 v[36:37], v4 offset:0
    v_mfma_f32_16x16x32_bf16 v[100:103], v[52:55], v[84:87], v[100:103]
    ds_read_b64_tr_b16 v[38:39], v4 offset:1024
    v_mfma_f32_16x16x32_bf16 v[104:107], v[52:55], v[88:91], v[104:107]
    ds_read_b64_tr_b16 v[40:41], v5 offset:0
    v_mfma_f32_16x16x32_bf16 v[108:111], v[52:55], v[92:95], v[108:111]
    ds_read_b64_tr_b16 v[42:43], v5 offset:1024
    v_mfma_f32_16x16x32_bf16 v[112:115], v[56:59], v[80:83], v[112:115]
    ds_read_b64_tr_b16 v[44:45], v6 offset:0
    v_mfma_f32_16x16x32_bf16 v[116:119], v[56:59], v[84:87], v[116:119]
    ds_read_b64_tr_b16 v[46:47], v6 offset:1024
    v_mfma_f32_16x16x32_bf16 v[120:123], v[56:59], v[88:91], v[120:123]
    ds_read_b64_tr_b16 v[48:49], v7 offset:0
    v_mfma_f32_16x16x32_bf16 v[124:127], v[56:59], v[92:95], v[124:127]
    ds_read_b64_tr_b16 v[50:51], v7 offset:1024
    v_mfma_f32_16x16x32_bf16 v[128:131], v[60:63], v[80:83], v[128:131]
    ds_read_b64_tr_b16 v[8:9], v2 offset:0
    v_mfma_f32_16x16x32_bf16 v[132:135], v[60:63], v[84:87], v[132:135]
    ds_read_b64_tr_b16 v[10:11], v2 offset:1792
    v_mfma_f32_16x16x32_bf16 v[136:139], v[60:63], v[88:91], v[136:139]
    ds_read_b64_tr_b16 v[12:13], v3 offset:32
    v_mfma_f32_16x16x32_bf16 v[140:143], v[60:63], v[92:95], v[140:143]
    ds_read_b64_tr_b16 v[14:15], v3 offset:1824
    v_mfma_f32_16x16x32_bf16 v[144:147], v[64:67], v[80:83], v[144:147]
    ds_read_b64_tr_b16 v[16:17], v2 offset:64
    v_mfma_f32_16x16x32_bf16 v[148:151], v[64:67], v[84:87], v[148:151]
    ds_read_b64_tr_b16 v[18:19], v2 offset:1856
    v_mfma_f32_16x16x32_bf16 v[152:155], v[64:67], v[88:91], v[152:155]
    ds_read_b64_tr_b16 v[20:21], v3 offset:96
    v_mfma_f32_16x16x32_bf16 v[156:159], v[64:67], v[92:95], v[156:159]
    ds_read_b64_tr_b16 v[22:23], v3 offset:1888
    v_mfma_f32_16x16x32_bf16 v[160:163], v[68:71], v[80:83], v[160:163]
    ds_read_b64_tr_b16 v[24:25], v2 offset:128
    v_mfma_f32_16x16x32_bf16 v[164:167], v[68:71], v[84:87], v[164:167]
    ds_read_b64_tr_b16 v[26:27], v2 offset:1920
    v_mfma_f32_16x16x32_bf16 v[168:171], v[68:71], v[88:91], v[168:171]
    ds_read_b64_tr_b16 v[28:29], v3 offset:160
    v_mfma_f32_16x16x32_bf16 v[172:175], v[68:71], v[92:95], v[172:175]
    ds_read_b64_tr_b16 v[30:31], v3 offset:1952
    v_mfma_f32_16x16x32_bf16 v[176:179], v[72:75], v[80:83], v[176:179]
    ds_read_b64_tr_b16 v[32:33], v2 offset:192
    v_mfma_f32_16x16x32_bf16 v[180:183], v[72:75], v[84:87], v[180:183]
    ds_read_b64_tr_b16 v[34:35], v2 offset:1984
    v_mfma_f32_16x16x32_bf16 v[184:187], v[72:75], v[88:91], v[184:187]
    v_mfma_f32_16x16x32_bf16 v[188:191], v[72:75], v[92:95], v[188:191]
    v_mfma_f32_16x16x32_bf16 v[192:195], v[76:79], v[80:83], v[192:195]
    v_mfma_f32_16x16x32_bf16 v[196:199], v[76:79], v[84:87], v[196:199]
    v_mfma_f32_16x16x32_bf16 v[200:203], v[76:79], v[88:91], v[200:203]
    v_mfma_f32_16x16x32_bf16 v[204:207], v[76:79], v[92:95], v[204:207]
    s_waitcnt lgkmcnt(4)
    v_mfma_f32_16x16x32_bf16 v[96:99], v[8:11], v[36:39], v[96:99]
    ds_read_b64_tr_b16 v[80:81], v4 offset:8192
    v_mfma_f32_16x16x32_bf16 v[100:103], v[8:11], v[40:43], v[100:103]
    ds_read_b64_tr_b16 v[82:83], v4 offset:9216
    v_mfma_f32_16x16x32_bf16 v[104:107], v[8:11], v[44:47], v[104:107]
    ds_read_b64_tr_b16 v[84:85], v5 offset:8192
    v_mfma_f32_16x16x32_bf16 v[108:111], v[8:11], v[48:51], v[108:111]
    ds_read_b64_tr_b16 v[86:87], v5 offset:9216
    v_mfma_f32_16x16x32_bf16 v[112:115], v[12:15], v[36:39], v[112:115]
    ds_read_b64_tr_b16 v[88:89], v6 offset:8192
    v_mfma_f32_16x16x32_bf16 v[116:119], v[12:15], v[40:43], v[116:119]
    ds_read_b64_tr_b16 v[90:91], v6 offset:9216
    v_mfma_f32_16x16x32_bf16 v[120:123], v[12:15], v[44:47], v[120:123]
    ds_read_b64_tr_b16 v[92:93], v7 offset:8192
    v_mfma_f32_16x16x32_bf16 v[124:127], v[12:15], v[48:51], v[124:127]
    ds_read_b64_tr_b16 v[94:95], v7 offset:9216
    v_mfma_f32_16x16x32_bf16 v[128:131], v[16:19], v[36:39], v[128:131]
    ds_read_b64_tr_b16 v[52:53], v2 offset:14336
    v_mfma_f32_16x16x32_bf16 v[132:135], v[16:19], v[40:43], v[132:135]
    ds_read_b64_tr_b16 v[54:55], v2 offset:16128
    v_mfma_f32_16x16x32_bf16 v[136:139], v[16:19], v[44:47], v[136:139]
    ds_read_b64_tr_b16 v[56:57], v3 offset:14368
    v_mfma_f32_16x16x32_bf16 v[140:143], v[16:19], v[48:51], v[140:143]
    ds_read_b64_tr_b16 v[58:59], v3 offset:16160
    v_mfma_f32_16x16x32_bf16 v[144:147], v[20:23], v[36:39], v[144:147]
    ds_read_b64_tr_b16 v[60:61], v2 offset:14400
    v_mfma_f32_16x16x32_bf16 v[148:151], v[20:23], v[40:43], v[148:151]
    ds_read_b64_tr_b16 v[62:63], v2 offset:16192
    v_mfma_f32_16x16x32_bf16 v[152:155], v[20:23], v[44:47], v[152:155]
    ds_read_b64_tr_b16 v[64:65], v3 offset:14432
    v_mfma_f32_16x16x32_bf16 v[156:159], v[20:23], v[48:51], v[156:159]
    ds_read_b64_tr_b16 v[66:67], v3 offset:16224
    v_mfma_f32_16x16x32_bf16 v[160:163], v[24:27], v[36:39], v[160:163]
    ds_read_b64_tr_b16 v[68:69], v2 offset:14464
    v_mfma_f32_16x16x32_bf16 v[164:167], v[24:27], v[40:43], v[164:167]
    ds_read_b64_tr_b16 v[70:71], v2 offset:16256
    v_mfma_f32_16x16x32_bf16 v[168:171], v[24:27], v[44:47], v[168:171]
    ds_read_b64_tr_b16 v[72:73], v3 offset:14496
    v_mfma_f32_16x16x32_bf16 v[172:175], v[24:27], v[48:51], v[172:175]
    ds_read_b64_tr_b16 v[74:75], v3 offset:16288
    s_waitcnt lgkmcnt(15)
    v_mfma_f32_16x16x32_bf16 v[176:179], v[28:31], v[36:39], v[176:179]
    ds_read_b64_tr_b16 v[76:77], v2 offset:14528
    v_mfma_f32_16x16x32_bf16 v[180:183], v[28:31], v[40:43], v[180:183]
    ds_read_b64_tr_b16 v[78:79], v2 offset:16320
    v_mfma_f32_16x16x32_bf16 v[184:187], v[28:31], v[44:47], v[184:187]
    v_add_u32 v2, 0xfffea000, v2
    v_mfma_f32_16x16x32_bf16 v[188:191], v[28:31], v[48:51], v[188:191]
    v_add_u32 v3, 0xfffea000, v3
    v_mfma_f32_16x16x32_bf16 v[192:195], v[32:35], v[36:39], v[192:195]
    v_add_u32 v4, 0xfffea000, v4
    v_mfma_f32_16x16x32_bf16 v[196:199], v[32:35], v[40:43], v[196:199]
    v_add_u32 v5, 0xfffea000, v5
    v_mfma_f32_16x16x32_bf16 v[200:203], v[32:35], v[44:47], v[200:203]
    v_add_u32 v6, 0xfffea000, v6
    v_mfma_f32_16x16x32_bf16 v[204:207], v[32:35], v[48:51], v[204:207]
    v_add_u32 v7, 0xfffea000, v7
    s_waitcnt vmcnt(0) lgkmcnt(0)
    s_barrier
    v_mfma_f32_16x16x32_bf16 v[96:99], v[52:55], v[80:83], v[96:99]
    ds_read_b64_tr_b16 v[36:37], v4 offset:0
    v_mfma_f32_16x16x32_bf16 v[100:103], v[52:55], v[84:87], v[100:103]
    ds_read_b64_tr_b16 v[38:39], v4 offset:1024
    v_mfma_f32_16x16x32_bf16 v[104:107], v[52:55], v[88:91], v[104:107]
    ds_read_b64_tr_b16 v[40:41], v5 offset:0
    v_mfma_f32_16x16x32_bf16 v[108:111], v[52:55], v[92:95], v[108:111]
    ds_read_b64_tr_b16 v[42:43], v5 offset:1024
    v_mfma_f32_16x16x32_bf16 v[112:115], v[56:59], v[80:83], v[112:115]
    ds_read_b64_tr_b16 v[44:45], v6 offset:0
    v_mfma_f32_16x16x32_bf16 v[116:119], v[56:59], v[84:87], v[116:119]
    ds_read_b64_tr_b16 v[46:47], v6 offset:1024
    v_mfma_f32_16x16x32_bf16 v[120:123], v[56:59], v[88:91], v[120:123]
    ds_read_b64_tr_b16 v[48:49], v7 offset:0
    v_mfma_f32_16x16x32_bf16 v[124:127], v[56:59], v[92:95], v[124:127]
    ds_read_b64_tr_b16 v[50:51], v7 offset:1024
    v_mfma_f32_16x16x32_bf16 v[128:131], v[60:63], v[80:83], v[128:131]
    ds_read_b64_tr_b16 v[8:9], v2 offset:0
    v_mfma_f32_16x16x32_bf16 v[132:135], v[60:63], v[84:87], v[132:135]
    ds_read_b64_tr_b16 v[10:11], v2 offset:1792
    v_mfma_f32_16x16x32_bf16 v[136:139], v[60:63], v[88:91], v[136:139]
    ds_read_b64_tr_b16 v[12:13], v3 offset:32
    v_mfma_f32_16x16x32_bf16 v[140:143], v[60:63], v[92:95], v[140:143]
    ds_read_b64_tr_b16 v[14:15], v3 offset:1824
    v_mfma_f32_16x16x32_bf16 v[144:147], v[64:67], v[80:83], v[144:147]
    ds_read_b64_tr_b16 v[16:17], v2 offset:64
    v_mfma_f32_16x16x32_bf16 v[148:151], v[64:67], v[84:87], v[148:151]
    ds_read_b64_tr_b16 v[18:19], v2 offset:1856
    v_mfma_f32_16x16x32_bf16 v[152:155], v[64:67], v[88:91], v[152:155]
    ds_read_b64_tr_b16 v[20:21], v3 offset:96
    v_mfma_f32_16x16x32_bf16 v[156:159], v[64:67], v[92:95], v[156:159]
    ds_read_b64_tr_b16 v[22:23], v3 offset:1888
    v_mfma_f32_16x16x32_bf16 v[160:163], v[68:71], v[80:83], v[160:163]
    ds_read_b64_tr_b16 v[24:25], v2 offset:128
    v_mfma_f32_16x16x32_bf16 v[164:167], v[68:71], v[84:87], v[164:167]
    ds_read_b64_tr_b16 v[26:27], v2 offset:1920
    v_mfma_f32_16x16x32_bf16 v[168:171], v[68:71], v[88:91], v[168:171]
    ds_read_b64_tr_b16 v[28:29], v3 offset:160
    v_mfma_f32_16x16x32_bf16 v[172:175], v[68:71], v[92:95], v[172:175]
    ds_read_b64_tr_b16 v[30:31], v3 offset:1952
    v_mfma_f32_16x16x32_bf16 v[176:179], v[72:75], v[80:83], v[176:179]
    ds_read_b64_tr_b16 v[32:33], v2 offset:192
    v_mfma_f32_16x16x32_bf16 v[180:183], v[72:75], v[84:87], v[180:183]
    ds_read_b64_tr_b16 v[34:35], v2 offset:1984
    v_mfma_f32_16x16x32_bf16 v[184:187], v[72:75], v[88:91], v[184:187]
    v_mfma_f32_16x16x32_bf16 v[188:191], v[72:75], v[92:95], v[188:191]
    v_mfma_f32_16x16x32_bf16 v[192:195], v[76:79], v[80:83], v[192:195]
    v_mfma_f32_16x16x32_bf16 v[196:199], v[76:79], v[84:87], v[196:199]
    v_mfma_f32_16x16x32_bf16 v[200:203], v[76:79], v[88:91], v[200:203]
    v_mfma_f32_16x16x32_bf16 v[204:207], v[76:79], v[92:95], v[204:207]
    s_waitcnt lgkmcnt(4)
    v_mfma_f32_16x16x32_bf16 v[96:99], v[8:11], v[36:39], v[96:99]
    ds_read_b64_tr_b16 v[80:81], v4 offset:8192
    v_mfma_f32_16x16x32_bf16 v[100:103], v[8:11], v[40:43], v[100:103]
    ds_read_b64_tr_b16 v[82:83], v4 offset:9216
    v_mfma_f32_16x16x32_bf16 v[104:107], v[8:11], v[44:47], v[104:107]
    ds_read_b64_tr_b16 v[84:85], v5 offset:8192
    v_mfma_f32_16x16x32_bf16 v[108:111], v[8:11], v[48:51], v[108:111]
    ds_read_b64_tr_b16 v[86:87], v5 offset:9216
    v_mfma_f32_16x16x32_bf16 v[112:115], v[12:15], v[36:39], v[112:115]
    ds_read_b64_tr_b16 v[88:89], v6 offset:8192
    v_mfma_f32_16x16x32_bf16 v[116:119], v[12:15], v[40:43], v[116:119]
    ds_read_b64_tr_b16 v[90:91], v6 offset:9216
    v_mfma_f32_16x16x32_bf16 v[120:123], v[12:15], v[44:47], v[120:123]
    ds_read_b64_tr_b16 v[92:93], v7 offset:8192
    v_mfma_f32_16x16x32_bf16 v[124:127], v[12:15], v[48:51], v[124:127]
    ds_read_b64_tr_b16 v[94:95], v7 offset:9216
    v_mfma_f32_16x16x32_bf16 v[128:131], v[16:19], v[36:39], v[128:131]
    ds_read_b64_tr_b16 v[52:53], v2 offset:14336
    v_mfma_f32_16x16x32_bf16 v[132:135], v[16:19], v[40:43], v[132:135]
    ds_read_b64_tr_b16 v[54:55], v2 offset:16128
    v_mfma_f32_16x16x32_bf16 v[136:139], v[16:19], v[44:47], v[136:139]
    ds_read_b64_tr_b16 v[56:57], v3 offset:14368
    v_mfma_f32_16x16x32_bf16 v[140:143], v[16:19], v[48:51], v[140:143]
    ds_read_b64_tr_b16 v[58:59], v3 offset:16160
    v_mfma_f32_16x16x32_bf16 v[144:147], v[20:23], v[36:39], v[144:147]
    ds_read_b64_tr_b16 v[60:61], v2 offset:14400
    v_mfma_f32_16x16x32_bf16 v[148:151], v[20:23], v[40:43], v[148:151]
    ds_read_b64_tr_b16 v[62:63], v2 offset:16192
    v_mfma_f32_16x16x32_bf16 v[152:155], v[20:23], v[44:47], v[152:155]
    ds_read_b64_tr_b16 v[64:65], v3 offset:14432
    v_mfma_f32_16x16x32_bf16 v[156:159], v[20:23], v[48:51], v[156:159]
    ds_read_b64_tr_b16 v[66:67], v3 offset:16224
    v_mfma_f32_16x16x32_bf16 v[160:163], v[24:27], v[36:39], v[160:163]
    ds_read_b64_tr_b16 v[68:69], v2 offset:14464
    v_mfma_f32_16x16x32_bf16 v[164:167], v[24:27], v[40:43], v[164:167]
    ds_read_b64_tr_b16 v[70:71], v2 offset:16256
    v_mfma_f32_16x16x32_bf16 v[168:171], v[24:27], v[44:47], v[168:171]
    ds_read_b64_tr_b16 v[72:73], v3 offset:14496
    v_mfma_f32_16x16x32_bf16 v[172:175], v[24:27], v[48:51], v[172:175]
    ds_read_b64_tr_b16 v[74:75], v3 offset:16288
    s_waitcnt lgkmcnt(15)
    v_mfma_f32_16x16x32_bf16 v[176:179], v[28:31], v[36:39], v[176:179]
    ds_read_b64_tr_b16 v[76:77], v2 offset:14528
    v_mfma_f32_16x16x32_bf16 v[180:183], v[28:31], v[40:43], v[180:183]
    ds_read_b64_tr_b16 v[78:79], v2 offset:16320
    v_mfma_f32_16x16x32_bf16 v[184:187], v[28:31], v[44:47], v[184:187]
    v_add_u32 v2, 0xb000, v2
    v_mfma_f32_16x16x32_bf16 v[188:191], v[28:31], v[48:51], v[188:191]
    v_add_u32 v3, 0xb000, v3
    v_mfma_f32_16x16x32_bf16 v[192:195], v[32:35], v[36:39], v[192:195]
    v_add_u32 v4, 0xb000, v4
    v_mfma_f32_16x16x32_bf16 v[196:199], v[32:35], v[40:43], v[196:199]
    v_add_u32 v5, 0xb000, v5
    v_mfma_f32_16x16x32_bf16 v[200:203], v[32:35], v[44:47], v[200:203]
    v_add_u32 v6, 0xb000, v6
    v_mfma_f32_16x16x32_bf16 v[204:207], v[32:35], v[48:51], v[204:207]
    s_add_u32 s67, s67, 1
    v_add_u32 v7, 0xb000, v7
    s_cmp_lt_u32 s67, 5
    s_waitcnt lgkmcnt(0)
    s_barrier
    s_cbranch_scc1 L_g1c_60
    v_mfma_f32_16x16x32_bf16 v[96:99], v[52:55], v[80:83], v[96:99]
    v_mfma_f32_16x16x32_bf16 v[100:103], v[52:55], v[84:87], v[100:103]
    v_mfma_f32_16x16x32_bf16 v[104:107], v[52:55], v[88:91], v[104:107]
    v_mfma_f32_16x16x32_bf16 v[108:111], v[52:55], v[92:95], v[108:111]
    v_mfma_f32_16x16x32_bf16 v[112:115], v[56:59], v[80:83], v[112:115]
    v_mfma_f32_16x16x32_bf16 v[116:119], v[56:59], v[84:87], v[116:119]
    v_mfma_f32_16x16x32_bf16 v[120:123], v[56:59], v[88:91], v[120:123]
    v_mfma_f32_16x16x32_bf16 v[124:127], v[56:59], v[92:95], v[124:127]
    v_mfma_f32_16x16x32_bf16 v[128:131], v[60:63], v[80:83], v[128:131]
    v_mfma_f32_16x16x32_bf16 v[132:135], v[60:63], v[84:87], v[132:135]
    v_mfma_f32_16x16x32_bf16 v[136:139], v[60:63], v[88:91], v[136:139]
    v_mfma_f32_16x16x32_bf16 v[140:143], v[60:63], v[92:95], v[140:143]
    v_mfma_f32_16x16x32_bf16 v[144:147], v[64:67], v[80:83], v[144:147]
    v_mfma_f32_16x16x32_bf16 v[148:151], v[64:67], v[84:87], v[148:151]
    v_mfma_f32_16x16x32_bf16 v[152:155], v[64:67], v[88:91], v[152:155]
    v_mfma_f32_16x16x32_bf16 v[156:159], v[64:67], v[92:95], v[156:159]
    v_mfma_f32_16x16x32_bf16 v[160:163], v[68:71], v[80:83], v[160:163]
    v_mfma_f32_16x16x32_bf16 v[164:167], v[68:71], v[84:87], v[164:167]
    v_mfma_f32_16x16x32_bf16 v[168:171], v[68:71], v[88:91], v[168:171]
    v_mfma_f32_16x16x32_bf16 v[172:175], v[68:71], v[92:95], v[172:175]
    v_mfma_f32_16x16x32_bf16 v[176:179], v[72:75], v[80:83], v[176:179]
    v_mfma_f32_16x16x32_bf16 v[180:183], v[72:75], v[84:87], v[180:183]
    v_mfma_f32_16x16x32_bf16 v[184:187], v[72:75], v[88:91], v[184:187]
    v_mfma_f32_16x16x32_bf16 v[188:191], v[72:75], v[92:95], v[188:191]
    v_mfma_f32_16x16x32_bf16 v[192:195], v[76:79], v[80:83], v[192:195]
    v_mfma_f32_16x16x32_bf16 v[196:199], v[76:79], v[84:87], v[196:199]
    v_mfma_f32_16x16x32_bf16 v[200:203], v[76:79], v[88:91], v[200:203]
    v_mfma_f32_16x16x32_bf16 v[204:207], v[76:79], v[92:95], v[204:207]
    s_barrier
    v_and_b32 v2, 15, v0
    v_lshrrev_b32 v3, 4, v0
    s_lshl_b32 s56, s59, 9
    s_add_u32 s56, s56, 135168
    v_lshl_add_u32 v4, v2, 3, s56
    ds_read_b64 v[8:9], v4 offset:0
    ds_read_b64 v[10:11], v4 offset:128
    ds_read_b64 v[12:13], v4 offset:256
    ds_read_b64 v[14:15], v4 offset:384
    s_mul_i32 s56, s58, 448
    s_add_u32 s56, s56, 136192
    v_lshl_add_u32 v5, v3, 4, s56
    ds_read_b128 v[16:19], v5 offset:0
    ds_read_b128 v[20:23], v5 offset:1024
    ds_read_b128 v[24:27], v5 offset:64
    ds_read_b128 v[28:31], v5 offset:1088
    ds_read_b128 v[32:35], v5 offset:128
    ds_read_b128 v[36:39], v5 offset:1152
    ds_read_b128 v[40:43], v5 offset:192
    ds_read_b128 v[44:47], v5 offset:1216
    ds_read_b128 v[48:51], v5 offset:256
    ds_read_b128 v[52:55], v5 offset:1280
    ds_read_b128 v[56:59], v5 offset:320
    ds_read_b128 v[60:63], v5 offset:1344
    ds_read_b128 v[64:67], v5 offset:384
    ds_read_b128 v[68:71], v5 offset:1408
    v_mov_b32 v72, 0xbdd2d3e8
    v_mov_b32 v73, 0xbdd2d3e8
    v_mov_b32 v74, 0xc0135761
    v_mov_b32 v75, 0xc0135761
    v_mov_b32 v76, 0x3f800000
    v_mov_b32 v77, 0x3f800000
    v_and_b32 v79, 1, v3
    v_lshrrev_b32 v81, 1, v3
    v_lshl_add_u32 v80, v79, 1, v81
    v_lshlrev_b32 v80, 11, v80
    v_lshl_add_u32 v82, v2, 4, v80
    s_lshl_b32 s56, s58, 1
    v_add_u32 v80, s56, v81
    v_lshlrev_b32 v80, 11, v80
    v_lshl_add_u32 v80, v79, 8, v80
    v_lshl_add_u32 v83, v2, 4, v80
    s_mul_i32 s62, s60, 112
    s_mul_i32 s56, s61, 7
    s_add_u32 s62, s62, s56
    s_lshl_b32 s62, s62, 13
    s_lshl_b32 s56, s59, 10
    s_add_u32 s62, s62, s56
    s_add_u32 s62, s62, 13631488
    s_mul_i32 s56, s58, 3*8192
    s_add_u32 s63, s62, s56
    s_mul_i32 s56, s58, 3
    s_add_u32 s56, s56, 0
    s_lshr_b32 s57, s56, 1
    s_lshl_b32 s57, s57, 15
    s_and_b32 s56, s56, 1
    s_lshl_b32 s56, s56, 13
    s_add_u32 s56, s56, s57
    s_lshl_b32 s57, s59, 10
    s_add_u32 s56, s56, s57
    v_add_u32 v84, s56, v82
    s_mul_i32 s56, s58, 3
    s_add_u32 s56, s56, 1
    s_lshr_b32 s57, s56, 1
    s_lshl_b32 s57, s57, 15
    s_and_b32 s56, s56, 1
    s_lshl_b32 s56, s56, 13
    s_add_u32 s56, s56, s57
    s_lshl_b32 s57, s59, 10
    s_add_u32 s56, s56, s57
    v_add_u32 v85, s56, v82
    s_mul_i32 s56, s58, 3
    s_add_u32 s56, s56, 2
    s_lshr_b32 s57, s56, 1
    s_lshl_b32 s57, s57, 15
    s_and_b32 s56, s56, 1
    s_lshl_b32 s56, s56, 13
    s_add_u32 s56, s56, s57
    s_lshl_b32 s57, s59, 10
    s_add_u32 s56, s56, s57
    v_add_u32 v86, s56, v82
    s_waitcnt lgkmcnt(0)
    v_pk_fma_f32 v[216:217], v[8:9], v[16:17], v[20:21] op_sel:[1,0,0] op_sel_hi:[1,1,1] neg_lo:[1,0,0] neg_hi:[1,0,0]
    v_pk_fma_f32 v[218:219], v[8:9], v[18:19], v[22:23] op_sel:[1,0,0] op_sel_hi:[1,1,1] neg_lo:[1,0,0] neg_hi:[1,0,0]
    v_pk_fma_f32 v[96:97], v[8:9], v[96:97], v[216:217] op_sel:[0,0,0] op_sel_hi:[0,1,1]
    v_pk_fma_f32 v[98:99], v[8:9], v[98:99], v[218:219] op_sel:[0,0,0] op_sel_hi:[0,1,1]
    v_pk_mul_f32 v[216:217], v[96:97], v[96:97]
    v_pk_mul_f32 v[218:219], v[98:99], v[98:99]
    v_pk_fma_f32 v[216:217], v[216:217], v[72:73], v[74:75]
    v_pk_fma_f32 v[218:219], v[218:219], v[72:73], v[74:75]
    v_pk_mul_f32 v[216:217], v[216:217], v[96:97]
    v_pk_mul_f32 v[218:219], v[218:219], v[98:99]
    v_exp_f32 v216, v216
    v_exp_f32 v217, v217
    v_exp_f32 v218, v218
    v_exp_f32 v219, v219
    v_pk_add_f32 v[216:217], v[216:217], v[76:77]
    v_pk_add_f32 v[218:219], v[218:219], v[76:77]
    v_rcp_f32 v216, v216
    v_rcp_f32 v217, v217
    v_rcp_f32 v218, v218
    v_rcp_f32 v219, v219
    v_pk_mul_f32 v[96:97], v[96:97], v[216:217]
    v_pk_mul_f32 v[98:99], v[98:99], v[218:219]
    v_cvt_pk_bf16_f32 v208, v96, v97
    v_cvt_pk_bf16_f32 v209, v98, v99
    v_pk_fma_f32 v[216:217], v[8:9], v[24:25], v[28:29] op_sel:[1,0,0] op_sel_hi:[1,1,1] neg_lo:[1,0,0] neg_hi:[1,0,0]
    v_pk_fma_f32 v[218:219], v[8:9], v[26:27], v[30:31] op_sel:[1,0,0] op_sel_hi:[1,1,1] neg_lo:[1,0,0] neg_hi:[1,0,0]
    v_pk_fma_f32 v[112:113], v[8:9], v[112:113], v[216:217] op_sel:[0,0,0] op_sel_hi:[0,1,1]
    v_pk_fma_f32 v[114:115], v[8:9], v[114:115], v[218:219] op_sel:[0,0,0] op_sel_hi:[0,1,1]
    v_pk_mul_f32 v[216:217], v[112:113], v[112:113]
    v_pk_mul_f32 v[218:219], v[114:115], v[114:115]
    v_pk_fma_f32 v[216:217], v[216:217], v[72:73], v[74:75]
    v_pk_fma_f32 v[218:219], v[218:219], v[72:73], v[74:75]
    v_pk_mul_f32 v[216:217], v[216:217], v[112:113]
    v_pk_mul_f32 v[218:219], v[218:219], v[114:115]
    v_exp_f32 v216, v216
    v_exp_f32 v217, v217
    v_exp_f32 v218, v218
    v_exp_f32 v219, v219
    v_pk_add_f32 v[216:217], v[216:217], v[76:77]
    v_pk_add_f32 v[218:219], v[218:219], v[76:77]
    v_rcp_f32 v216, v216
    v_rcp_f32 v217, v217
    v_rcp_f32 v218, v218
    v_rcp_f32 v219, v219
    v_pk_mul_f32 v[112:113], v[112:113], v[216:217]
    v_pk_mul_f32 v[114:115], v[114:115], v[218:219]
    v_cvt_pk_bf16_f32 v210, v112, v113
    v_cvt_pk_bf16_f32 v211, v114, v115
    s_nop 0
    v_permlane16_swap_b32 v208, v210
    v_permlane16_swap_b32 v209, v211
    s_add_u32 s56, s63, 0
    buffer_store_dwordx4 v[208:211], v82, s[36:39], s56 offen sc1
    ds_write_b128 v84, v[208:211] offset:0
    v_pk_fma_f32 v[220:221], v[10:11], v[16:17], v[20:21] op_sel:[1,0,0] op_sel_hi:[1,1,1] neg_lo:[1,0,0] neg_hi:[1,0,0]
    v_pk_fma_f32 v[222:223], v[10:11], v[18:19], v[22:23] op_sel:[1,0,0] op_sel_hi:[1,1,1] neg_lo:[1,0,0] neg_hi:[1,0,0]
    v_pk_fma_f32 v[100:101], v[10:11], v[100:101], v[220:221] op_sel:[0,0,0] op_sel_hi:[0,1,1]
    v_pk_fma_f32 v[102:103], v[10:11], v[102:103], v[222:223] op_sel:[0,0,0] op_sel_hi:[0,1,1]
    v_pk_mul_f32 v[220:221], v[100:101], v[100:101]
    v_pk_mul_f32 v[222:223], v[102:103], v[102:103]
    v_pk_fma_f32 v[220:221], v[220:221], v[72:73], v[74:75]
    v_pk_fma_f32 v[222:223], v[222:223], v[72:73], v[74:75]
    v_pk_mul_f32 v[220:221], v[220:221], v[100:101]
    v_pk_mul_f32 v[222:223], v[222:223], v[102:103]
    v_exp_f32 v220, v220
    v_exp_f32 v221, v221
    v_exp_f32 v222, v222
    v_exp_f32 v223, v223
    v_pk_add_f32 v[220:221], v[220:221], v[76:77]
    v_pk_add_f32 v[222:223], v[222:223], v[76:77]
    v_rcp_f32 v220, v220
    v_rcp_f32 v221, v221
    v_rcp_f32 v222, v222
    v_rcp_f32 v223, v223
    v_pk_mul_f32 v[100:101], v[100:101], v[220:221]
    v_pk_mul_f32 v[102:103], v[102:103], v[222:223]
    v_cvt_pk_bf16_f32 v212, v100, v101
    v_cvt_pk_bf16_f32 v213, v102, v103
    v_pk_fma_f32 v[220:221], v[10:11], v[24:25], v[28:29] op_sel:[1,0,0] op_sel_hi:[1,1,1] neg_lo:[1,0,0] neg_hi:[1,0,0]
    v_pk_fma_f32 v[222:223], v[10:11], v[26:27], v[30:31] op_sel:[1,0,0] op_sel_hi:[1,1,1] neg_lo:[1,0,0] neg_hi:[1,0,0]
    v_pk_fma_f32 v[116:117], v[10:11], v[116:117], v[220:221] op_sel:[0,0,0] op_sel_hi:[0,1,1]
    v_pk_fma_f32 v[118:119], v[10:11], v[118:119], v[222:223] op_sel:[0,0,0] op_sel_hi:[0,1,1]
    v_pk_mul_f32 v[220:221], v[116:117], v[116:117]
    v_pk_mul_f32 v[222:223], v[118:119], v[118:119]
    v_pk_fma_f32 v[220:221], v[220:221], v[72:73], v[74:75]
    v_pk_fma_f32 v[222:223], v[222:223], v[72:73], v[74:75]
    v_pk_mul_f32 v[220:221], v[220:221], v[116:117]
    v_pk_mul_f32 v[222:223], v[222:223], v[118:119]
    v_exp_f32 v220, v220
    v_exp_f32 v221, v221
    v_exp_f32 v222, v222
    v_exp_f32 v223, v223
    v_pk_add_f32 v[220:221], v[220:221], v[76:77]
    v_pk_add_f32 v[222:223], v[222:223], v[76:77]
    v_rcp_f32 v220, v220
    v_rcp_f32 v221, v221
    v_rcp_f32 v222, v222
    v_rcp_f32 v223, v223
    v_pk_mul_f32 v[116:117], v[116:117], v[220:221]
    v_pk_mul_f32 v[118:119], v[118:119], v[222:223]
    v_cvt_pk_bf16_f32 v214, v116, v117
    v_cvt_pk_bf16_f32 v215, v118, v119
    s_nop 0
    v_permlane16_swap_b32 v212, v214
    v_permlane16_swap_b32 v213, v215
    s_add_u32 s56, s63, 256
    buffer_store_dwordx4 v[212:215], v82, s[36:39], s56 offen sc1
    ds_write_b128 v84, v[212:215] offset:256
    v_pk_fma_f32 v[216:217], v[12:13], v[16:17], v[20:21] op_sel:[1,0,0] op_sel_hi:[1,1,1] neg_lo:[1,0,0] neg_hi:[1,0,0]
    v_pk_fma_f32 v[218:219], v[12:13], v[18:19], v[22:23] op_sel:[1,0,0] op_sel_hi:[1,1,1] neg_lo:[1,0,0] neg_hi:[1,0,0]
    v_pk_fma_f32 v[104:105], v[12:13], v[104:105], v[216:217] op_sel:[0,0,0] op_sel_hi:[0,1,1]
    v_pk_fma_f32 v[106:107], v[12:13], v[106:107], v[218:219] op_sel:[0,0,0] op_sel_hi:[0,1,1]
    v_pk_mul_f32 v[216:217], v[104:105], v[104:105]
    v_pk_mul_f32 v[218:219], v[106:107], v[106:107]
    v_pk_fma_f32 v[216:217], v[216:217], v[72:73], v[74:75]
    v_pk_fma_f32 v[218:219], v[218:219], v[72:73], v[74:75]
    v_pk_mul_f32 v[216:217], v[216:217], v[104:105]
    v_pk_mul_f32 v[218:219], v[218:219], v[106:107]
    v_exp_f32 v216, v216
    v_exp_f32 v217, v217
    v_exp_f32 v218, v218
    v_exp_f32 v219, v219
    v_pk_add_f32 v[216:217], v[216:217], v[76:77]
    v_pk_add_f32 v[218:219], v[218:219], v[76:77]
    v_rcp_f32 v216, v216
    v_rcp_f32 v217, v217
    v_rcp_f32 v218, v218
    v_rcp_f32 v219, v219
    v_pk_mul_f32 v[104:105], v[104:105], v[216:217]
    v_pk_mul_f32 v[106:107], v[106:107], v[218:219]
    v_cvt_pk_bf16_f32 v208, v104, v105
    v_cvt_pk_bf16_f32 v209, v106, v107
    v_pk_fma_f32 v[216:217], v[12:13], v[24:25], v[28:29] op_sel:[1,0,0] op_sel_hi:[1,1,1] neg_lo:[1,0,0] neg_hi:[1,0,0]
    v_pk_fma_f32 v[218:219], v[12:13], v[26:27], v[30:31] op_sel:[1,0,0] op_sel_hi:[1,1,1] neg_lo:[1,0,0] neg_hi:[1,0,0]
    v_pk_fma_f32 v[120:121], v[12:13], v[120:121], v[216:217] op_sel:[0,0,0] op_sel_hi:[0,1,1]
    v_pk_fma_f32 v[122:123], v[12:13], v[122:123], v[218:219] op_sel:[0,0,0] op_sel_hi:[0,1,1]
    v_pk_mul_f32 v[216:217], v[120:121], v[120:121]
    v_pk_mul_f32 v[218:219], v[122:123], v[122:123]
    v_pk_fma_f32 v[216:217], v[216:217], v[72:73], v[74:75]
    v_pk_fma_f32 v[218:219], v[218:219], v[72:73], v[74:75]
    v_pk_mul_f32 v[216:217], v[216:217], v[120:121]
    v_pk_mul_f32 v[218:219], v[218:219], v[122:123]
    v_exp_f32 v216, v216
    v_exp_f32 v217, v217
    v_exp_f32 v218, v218
    v_exp_f32 v219, v219
    v_pk_add_f32 v[216:217], v[216:217], v[76:77]
    v_pk_add_f32 v[218:219], v[218:219], v[76:77]
    v_rcp_f32 v216, v216
    v_rcp_f32 v217, v217
    v_rcp_f32 v218, v218
    v_rcp_f32 v219, v219
    v_pk_mul_f32 v[120:121], v[120:121], v[216:217]
    v_pk_mul_f32 v[122:123], v[122:123], v[218:219]
    v_cvt_pk_bf16_f32 v210, v120, v121
    v_cvt_pk_bf16_f32 v211, v122, v123
    s_nop 0
    v_permlane16_swap_b32 v208, v210
    v_permlane16_swap_b32 v209, v211
    s_add_u32 s56, s63, 512
    buffer_store_dwordx4 v[208:211], v82, s[36:39], s56 offen sc1
    ds_write_b128 v84, v[208:211] offset:512
    v_pk_fma_f32 v[220:221], v[14:15], v[16:17], v[20:21] op_sel:[1,0,0] op_sel_hi:[1,1,1] neg_lo:[1,0,0] neg_hi:[1,0,0]
    v_pk_fma_f32 v[222:223], v[14:15], v[18:19], v[22:23] op_sel:[1,0,0] op_sel_hi:[1,1,1] neg_lo:[1,0,0] neg_hi:[1,0,0]
    v_pk_fma_f32 v[108:109], v[14:15], v[108:109], v[220:221] op_sel:[0,0,0] op_sel_hi:[0,1,1]
    v_pk_fma_f32 v[110:111], v[14:15], v[110:111], v[222:223] op_sel:[0,0,0] op_sel_hi:[0,1,1]
    v_pk_mul_f32 v[220:221], v[108:109], v[108:109]
    v_pk_mul_f32 v[222:223], v[110:111], v[110:111]
    v_pk_fma_f32 v[220:221], v[220:221], v[72:73], v[74:75]
    v_pk_fma_f32 v[222:223], v[222:223], v[72:73], v[74:75]
    v_pk_mul_f32 v[220:221], v[220:221], v[108:109]
    v_pk_mul_f32 v[222:223], v[222:223], v[110:111]
    v_exp_f32 v220, v220
    v_exp_f32 v221, v221
    v_exp_f32 v222, v222
    v_exp_f32 v223, v223
    v_pk_add_f32 v[220:221], v[220:221], v[76:77]
    v_pk_add_f32 v[222:223], v[222:223], v[76:77]
    v_rcp_f32 v220, v220
    v_rcp_f32 v221, v221
    v_rcp_f32 v222, v222
    v_rcp_f32 v223, v223
    v_pk_mul_f32 v[108:109], v[108:109], v[220:221]
    v_pk_mul_f32 v[110:111], v[110:111], v[222:223]
    v_cvt_pk_bf16_f32 v212, v108, v109
    v_cvt_pk_bf16_f32 v213, v110, v111
    v_pk_fma_f32 v[220:221], v[14:15], v[24:25], v[28:29] op_sel:[1,0,0] op_sel_hi:[1,1,1] neg_lo:[1,0,0] neg_hi:[1,0,0]
    v_pk_fma_f32 v[222:223], v[14:15], v[26:27], v[30:31] op_sel:[1,0,0] op_sel_hi:[1,1,1] neg_lo:[1,0,0] neg_hi:[1,0,0]
    v_pk_fma_f32 v[124:125], v[14:15], v[124:125], v[220:221] op_sel:[0,0,0] op_sel_hi:[0,1,1]
    v_pk_fma_f32 v[126:127], v[14:15], v[126:127], v[222:223] op_sel:[0,0,0] op_sel_hi:[0,1,1]
    v_pk_mul_f32 v[220:221], v[124:125], v[124:125]
    v_pk_mul_f32 v[222:223], v[126:127], v[126:127]
    v_pk_fma_f32 v[220:221], v[220:221], v[72:73], v[74:75]
    v_pk_fma_f32 v[222:223], v[222:223], v[72:73], v[74:75]
    v_pk_mul_f32 v[220:221], v[220:221], v[124:125]
    v_pk_mul_f32 v[222:223], v[222:223], v[126:127]
    v_exp_f32 v220, v220
    v_exp_f32 v221, v221
    v_exp_f32 v222, v222
    v_exp_f32 v223, v223
    v_pk_add_f32 v[220:221], v[220:221], v[76:77]
    v_pk_add_f32 v[222:223], v[222:223], v[76:77]
    v_rcp_f32 v220, v220
    v_rcp_f32 v221, v221
    v_rcp_f32 v222, v222
    v_rcp_f32 v223, v223
    v_pk_mul_f32 v[124:125], v[124:125], v[220:221]
    v_pk_mul_f32 v[126:127], v[126:127], v[222:223]
    v_cvt_pk_bf16_f32 v214, v124, v125
    v_cvt_pk_bf16_f32 v215, v126, v127
    s_nop 0
    v_permlane16_swap_b32 v212, v214
    v_permlane16_swap_b32 v213, v215
    s_add_u32 s56, s63, 768
    buffer_store_dwordx4 v[212:215], v82, s[36:39], s56 offen sc1
    ds_write_b128 v84, v[212:215] offset:768
    v_pk_fma_f32 v[216:217], v[8:9], v[32:33], v[36:37] op_sel:[1,0,0] op_sel_hi:[1,1,1] neg_lo:[1,0,0] neg_hi:[1,0,0]
    v_pk_fma_f32 v[218:219], v[8:9], v[34:35], v[38:39] op_sel:[1,0,0] op_sel_hi:[1,1,1] neg_lo:[1,0,0] neg_hi:[1,0,0]
    v_pk_fma_f32 v[128:129], v[8:9], v[128:129], v[216:217] op_sel:[0,0,0] op_sel_hi:[0,1,1]
    v_pk_fma_f32 v[130:131], v[8:9], v[130:131], v[218:219] op_sel:[0,0,0] op_sel_hi:[0,1,1]
    v_pk_mul_f32 v[216:217], v[128:129], v[128:129]
    v_pk_mul_f32 v[218:219], v[130:131], v[130:131]
    v_pk_fma_f32 v[216:217], v[216:217], v[72:73], v[74:75]
    v_pk_fma_f32 v[218:219], v[218:219], v[72:73], v[74:75]
    v_pk_mul_f32 v[216:217], v[216:217], v[128:129]
    v_pk_mul_f32 v[218:219], v[218:219], v[130:131]
    v_exp_f32 v216, v216
    v_exp_f32 v217, v217
    v_exp_f32 v218, v218
    v_exp_f32 v219, v219
    v_pk_add_f32 v[216:217], v[216:217], v[76:77]
    v_pk_add_f32 v[218:219], v[218:219], v[76:77]
    v_rcp_f32 v216, v216
    v_rcp_f32 v217, v217
    v_rcp_f32 v218, v218
    v_rcp_f32 v219, v219
    v_pk_mul_f32 v[128:129], v[128:129], v[216:217]
    v_pk_mul_f32 v[130:131], v[130:131], v[218:219]
    v_cvt_pk_bf16_f32 v208, v128, v129
    v_cvt_pk_bf16_f32 v209, v130, v131
    v_pk_fma_f32 v[216:217], v[8:9], v[40:41], v[44:45] op_sel:[1,0,0] op_sel_hi:[1,1,1] neg_lo:[1,0,0] neg_hi:[1,0,0]
    v_pk_fma_f32 v[218:219], v[8:9], v[42:43], v[46:47] op_sel:[1,0,0] op_sel_hi:[1,1,1] neg_lo:[1,0,0] neg_hi:[1,0,0]
    v_pk_fma_f32 v[144:145], v[8:9], v[144:145], v[216:217] op_sel:[0,0,0] op_sel_hi:[0,1,1]
    v_pk_fma_f32 v[146:147], v[8:9], v[146:147], v[218:219] op_sel:[0,0,0] op_sel_hi:[0,1,1]
    v_pk_mul_f32 v[216:217], v[144:145], v[144:145]
    v_pk_mul_f32 v[218:219], v[146:147], v[146:147]
    v_pk_fma_f32 v[216:217], v[216:217], v[72:73], v[74:75]
    v_pk_fma_f32 v[218:219], v[218:219], v[72:73], v[74:75]
    v_pk_mul_f32 v[216:217], v[216:217], v[144:145]
    v_pk_mul_f32 v[218:219], v[218:219], v[146:147]
    v_exp_f32 v216, v216
    v_exp_f32 v217, v217
    v_exp_f32 v218, v218
    v_exp_f32 v219, v219
    v_pk_add_f32 v[216:217], v[216:217], v[76:77]
    v_pk_add_f32 v[218:219], v[218:219], v[76:77]
    v_rcp_f32 v216, v216
    v_rcp_f32 v217, v217
    v_rcp_f32 v218, v218
    v_rcp_f32 v219, v219
    v_pk_mul_f32 v[144:145], v[144:145], v[216:217]
    v_pk_mul_f32 v[146:147], v[146:147], v[218:219]
    v_cvt_pk_bf16_f32 v210, v144, v145
    v_cvt_pk_bf16_f32 v211, v146, v147
    s_nop 0
    v_permlane16_swap_b32 v208, v210
    v_permlane16_swap_b32 v209, v211
    s_add_u32 s56, s63, 8192
    buffer_store_dwordx4 v[208:211], v82, s[36:39], s56 offen sc1
    ds_write_b128 v85, v[208:211] offset:0
    v_pk_fma_f32 v[220:221], v[10:11], v[32:33], v[36:37] op_sel:[1,0,0] op_sel_hi:[1,1,1] neg_lo:[1,0,0] neg_hi:[1,0,0]
    v_pk_fma_f32 v[222:223], v[10:11], v[34:35], v[38:39] op_sel:[1,0,0] op_sel_hi:[1,1,1] neg_lo:[1,0,0] neg_hi:[1,0,0]
    v_pk_fma_f32 v[132:133], v[10:11], v[132:133], v[220:221] op_sel:[0,0,0] op_sel_hi:[0,1,1]
    v_pk_fma_f32 v[134:135], v[10:11], v[134:135], v[222:223] op_sel:[0,0,0] op_sel_hi:[0,1,1]
    v_pk_mul_f32 v[220:221], v[132:133], v[132:133]
    v_pk_mul_f32 v[222:223], v[134:135], v[134:135]
    v_pk_fma_f32 v[220:221], v[220:221], v[72:73], v[74:75]
    v_pk_fma_f32 v[222:223], v[222:223], v[72:73], v[74:75]
    v_pk_mul_f32 v[220:221], v[220:221], v[132:133]
    v_pk_mul_f32 v[222:223], v[222:223], v[134:135]
    v_exp_f32 v220, v220
    v_exp_f32 v221, v221
    v_exp_f32 v222, v222
    v_exp_f32 v223, v223
    v_pk_add_f32 v[220:221], v[220:221], v[76:77]
    v_pk_add_f32 v[222:223], v[222:223], v[76:77]
    v_rcp_f32 v220, v220
    v_rcp_f32 v221, v221
    v_rcp_f32 v222, v222
    v_rcp_f32 v223, v223
    v_pk_mul_f32 v[132:133], v[132:133], v[220:221]
    v_pk_mul_f32 v[134:135], v[134:135], v[222:223]
    v_cvt_pk_bf16_f32 v212, v132, v133
    v_cvt_pk_bf16_f32 v213, v134, v135
    v_pk_fma_f32 v[220:221], v[10:11], v[40:41], v[44:45] op_sel:[1,0,0] op_sel_hi:[1,1,1] neg_lo:[1,0,0] neg_hi:[1,0,0]
    v_pk_fma_f32 v[222:223], v[10:11], v[42:43], v[46:47] op_sel:[1,0,0] op_sel_hi:[1,1,1] neg_lo:[1,0,0] neg_hi:[1,0,0]
    v_pk_fma_f32 v[148:149], v[10:11], v[148:149], v[220:221] op_sel:[0,0,0] op_sel_hi:[0,1,1]
    v_pk_fma_f32 v[150:151], v[10:11], v[150:151], v[222:223] op_sel:[0,0,0] op_sel_hi:[0,1,1]
    v_pk_mul_f32 v[220:221], v[148:149], v[148:149]
    v_pk_mul_f32 v[222:223], v[150:151], v[150:151]
    v_pk_fma_f32 v[220:221], v[220:221], v[72:73], v[74:75]
    v_pk_fma_f32 v[222:223], v[222:223], v[72:73], v[74:75]
    v_pk_mul_f32 v[220:221], v[220:221], v[148:149]
    v_pk_mul_f32 v[222:223], v[222:223], v[150:151]
    v_exp_f32 v220, v220
    v_exp_f32 v221, v221
    v_exp_f32 v222, v222
    v_exp_f32 v223, v223
    v_pk_add_f32 v[220:221], v[220:221], v[76:77]
    v_pk_add_f32 v[222:223], v[222:223], v[76:77]
    v_rcp_f32 v220, v220
    v_rcp_f32 v221, v221
    v_rcp_f32 v222, v222
    v_rcp_f32 v223, v223
    v_pk_mul_f32 v[148:149], v[148:149], v[220:221]
    v_pk_mul_f32 v[150:151], v[150:151], v[222:223]
    v_cvt_pk_bf16_f32 v214, v148, v149
    v_cvt_pk_bf16_f32 v215, v150, v151
    s_nop 0
    v_permlane16_swap_b32 v212, v214
    v_permlane16_swap_b32 v213, v215
    s_add_u32 s56, s63, 8448
    buffer_store_dwordx4 v[212:215], v82, s[36:39], s56 offen sc1
    ds_write_b128 v85, v[212:215] offset:256
    v_pk_fma_f32 v[216:217], v[12:13], v[32:33], v[36:37] op_sel:[1,0,0] op_sel_hi:[1,1,1] neg_lo:[1,0,0] neg_hi:[1,0,0]
    v_pk_fma_f32 v[218:219], v[12:13], v[34:35], v[38:39] op_sel:[1,0,0] op_sel_hi:[1,1,1] neg_lo:[1,0,0] neg_hi:[1,0,0]
    v_pk_fma_f32 v[136:137], v[12:13], v[136:137], v[216:217] op_sel:[0,0,0] op_sel_hi:[0,1,1]
    v_pk_fma_f32 v[138:139], v[12:13], v[138:139], v[218:219] op_sel:[0,0,0] op_sel_hi:[0,1,1]
    v_pk_mul_f32 v[216:217], v[136:137], v[136:137]
    v_pk_mul_f32 v[218:219], v[138:139], v[138:139]
    v_pk_fma_f32 v[216:217], v[216:217], v[72:73], v[74:75]
    v_pk_fma_f32 v[218:219], v[218:219], v[72:73], v[74:75]
    v_pk_mul_f32 v[216:217], v[216:217], v[136:137]
    v_pk_mul_f32 v[218:219], v[218:219], v[138:139]
    v_exp_f32 v216, v216
    v_exp_f32 v217, v217
    v_exp_f32 v218, v218
    v_exp_f32 v219, v219
    v_pk_add_f32 v[216:217], v[216:217], v[76:77]
    v_pk_add_f32 v[218:219], v[218:219], v[76:77]
    v_rcp_f32 v216, v216
    v_rcp_f32 v217, v217
    v_rcp_f32 v218, v218
    v_rcp_f32 v219, v219
    v_pk_mul_f32 v[136:137], v[136:137], v[216:217]
    v_pk_mul_f32 v[138:139], v[138:139], v[218:219]
    v_cvt_pk_bf16_f32 v208, v136, v137
    v_cvt_pk_bf16_f32 v209, v138, v139
    v_pk_fma_f32 v[216:217], v[12:13], v[40:41], v[44:45] op_sel:[1,0,0] op_sel_hi:[1,1,1] neg_lo:[1,0,0] neg_hi:[1,0,0]
    v_pk_fma_f32 v[218:219], v[12:13], v[42:43], v[46:47] op_sel:[1,0,0] op_sel_hi:[1,1,1] neg_lo:[1,0,0] neg_hi:[1,0,0]
    v_pk_fma_f32 v[152:153], v[12:13], v[152:153], v[216:217] op_sel:[0,0,0] op_sel_hi:[0,1,1]
    v_pk_fma_f32 v[154:155], v[12:13], v[154:155], v[218:219] op_sel:[0,0,0] op_sel_hi:[0,1,1]
    v_pk_mul_f32 v[216:217], v[152:153], v[152:153]
    v_pk_mul_f32 v[218:219], v[154:155], v[154:155]
    v_pk_fma_f32 v[216:217], v[216:217], v[72:73], v[74:75]
    v_pk_fma_f32 v[218:219], v[218:219], v[72:73], v[74:75]
    v_pk_mul_f32 v[216:217], v[216:217], v[152:153]
    v_pk_mul_f32 v[218:219], v[218:219], v[154:155]
    v_exp_f32 v216, v216
    v_exp_f32 v217, v217
    v_exp_f32 v218, v218
    v_exp_f32 v219, v219
    v_pk_add_f32 v[216:217], v[216:217], v[76:77]
    v_pk_add_f32 v[218:219], v[218:219], v[76:77]
    v_rcp_f32 v216, v216
    v_rcp_f32 v217, v217
    v_rcp_f32 v218, v218
    v_rcp_f32 v219, v219
    v_pk_mul_f32 v[152:153], v[152:153], v[216:217]
    v_pk_mul_f32 v[154:155], v[154:155], v[218:219]
    v_cvt_pk_bf16_f32 v210, v152, v153
    v_cvt_pk_bf16_f32 v211, v154, v155
    s_nop 0
    v_permlane16_swap_b32 v208, v210
    v_permlane16_swap_b32 v209, v211
    s_add_u32 s56, s63, 8704
    buffer_store_dwordx4 v[208:211], v82, s[36:39], s56 offen sc1
    ds_write_b128 v85, v[208:211] offset:512
    v_pk_fma_f32 v[220:221], v[14:15], v[32:33], v[36:37] op_sel:[1,0,0] op_sel_hi:[1,1,1] neg_lo:[1,0,0] neg_hi:[1,0,0]
    v_pk_fma_f32 v[222:223], v[14:15], v[34:35], v[38:39] op_sel:[1,0,0] op_sel_hi:[1,1,1] neg_lo:[1,0,0] neg_hi:[1,0,0]
    v_pk_fma_f32 v[140:141], v[14:15], v[140:141], v[220:221] op_sel:[0,0,0] op_sel_hi:[0,1,1]
    v_pk_fma_f32 v[142:143], v[14:15], v[142:143], v[222:223] op_sel:[0,0,0] op_sel_hi:[0,1,1]
    v_pk_mul_f32 v[220:221], v[140:141], v[140:141]
    v_pk_mul_f32 v[222:223], v[142:143], v[142:143]
    v_pk_fma_f32 v[220:221], v[220:221], v[72:73], v[74:75]
    v_pk_fma_f32 v[222:223], v[222:223], v[72:73], v[74:75]
    v_pk_mul_f32 v[220:221], v[220:221], v[140:141]
    v_pk_mul_f32 v[222:223], v[222:223], v[142:143]
    v_exp_f32 v220, v220
    v_exp_f32 v221, v221
    v_exp_f32 v222, v222
    v_exp_f32 v223, v223
    v_pk_add_f32 v[220:221], v[220:221], v[76:77]
    v_pk_add_f32 v[222:223], v[222:223], v[76:77]
    v_rcp_f32 v220, v220
    v_rcp_f32 v221, v221
    v_rcp_f32 v222, v222
    v_rcp_f32 v223, v223
    v_pk_mul_f32 v[140:141], v[140:141], v[220:221]
    v_pk_mul_f32 v[142:143], v[142:143], v[222:223]
    v_cvt_pk_bf16_f32 v212, v140, v141
    v_cvt_pk_bf16_f32 v213, v142, v143
    v_pk_fma_f32 v[220:221], v[14:15], v[40:41], v[44:45] op_sel:[1,0,0] op_sel_hi:[1,1,1] neg_lo:[1,0,0] neg_hi:[1,0,0]
    v_pk_fma_f32 v[222:223], v[14:15], v[42:43], v[46:47] op_sel:[1,0,0] op_sel_hi:[1,1,1] neg_lo:[1,0,0] neg_hi:[1,0,0]
    v_pk_fma_f32 v[156:157], v[14:15], v[156:157], v[220:221] op_sel:[0,0,0] op_sel_hi:[0,1,1]
    v_pk_fma_f32 v[158:159], v[14:15], v[158:159], v[222:223] op_sel:[0,0,0] op_sel_hi:[0,1,1]
    v_pk_mul_f32 v[220:221], v[156:157], v[156:157]
    v_pk_mul_f32 v[222:223], v[158:159], v[158:159]
    v_pk_fma_f32 v[220:221], v[220:221], v[72:73], v[74:75]
    v_pk_fma_f32 v[222:223], v[222:223], v[72:73], v[74:75]
    v_pk_mul_f32 v[220:221], v[220:221], v[156:157]
    v_pk_mul_f32 v[222:223], v[222:223], v[158:159]
    v_exp_f32 v220, v220
    v_exp_f32 v221, v221
    v_exp_f32 v222, v222
    v_exp_f32 v223, v223
    v_pk_add_f32 v[220:221], v[220:221], v[76:77]
    v_pk_add_f32 v[222:223], v[222:223], v[76:77]
    v_rcp_f32 v220, v220
    v_rcp_f32 v221, v221
    v_rcp_f32 v222, v222
    v_rcp_f32 v223, v223
    v_pk_mul_f32 v[156:157], v[156:157], v[220:221]
    v_pk_mul_f32 v[158:159], v[158:159], v[222:223]
    v_cvt_pk_bf16_f32 v214, v156, v157
    v_cvt_pk_bf16_f32 v215, v158, v159
    s_nop 0
    v_permlane16_swap_b32 v212, v214
    v_permlane16_swap_b32 v213, v215
    s_add_u32 s56, s63, 8960
    buffer_store_dwordx4 v[212:215], v82, s[36:39], s56 offen sc1
    ds_write_b128 v85, v[212:215] offset:768
    v_pk_fma_f32 v[216:217], v[8:9], v[48:49], v[52:53] op_sel:[1,0,0] op_sel_hi:[1,1,1] neg_lo:[1,0,0] neg_hi:[1,0,0]
    v_pk_fma_f32 v[218:219], v[8:9], v[50:51], v[54:55] op_sel:[1,0,0] op_sel_hi:[1,1,1] neg_lo:[1,0,0] neg_hi:[1,0,0]
    v_pk_fma_f32 v[160:161], v[8:9], v[160:161], v[216:217] op_sel:[0,0,0] op_sel_hi:[0,1,1]
    v_pk_fma_f32 v[162:163], v[8:9], v[162:163], v[218:219] op_sel:[0,0,0] op_sel_hi:[0,1,1]
    v_pk_mul_f32 v[216:217], v[160:161], v[160:161]
    v_pk_mul_f32 v[218:219], v[162:163], v[162:163]
    v_pk_fma_f32 v[216:217], v[216:217], v[72:73], v[74:75]
    v_pk_fma_f32 v[218:219], v[218:219], v[72:73], v[74:75]
    v_pk_mul_f32 v[216:217], v[216:217], v[160:161]
    v_pk_mul_f32 v[218:219], v[218:219], v[162:163]
    v_exp_f32 v216, v216
    v_exp_f32 v217, v217
    v_exp_f32 v218, v218
    v_exp_f32 v219, v219
    v_pk_add_f32 v[216:217], v[216:217], v[76:77]
    v_pk_add_f32 v[218:219], v[218:219], v[76:77]
    v_rcp_f32 v216, v216
    v_rcp_f32 v217, v217
    v_rcp_f32 v218, v218
    v_rcp_f32 v219, v219
    v_pk_mul_f32 v[160:161], v[160:161], v[216:217]
    v_pk_mul_f32 v[162:163], v[162:163], v[218:219]
    v_cvt_pk_bf16_f32 v208, v160, v161
    v_cvt_pk_bf16_f32 v209, v162, v163
    v_pk_fma_f32 v[216:217], v[8:9], v[56:57], v[60:61] op_sel:[1,0,0] op_sel_hi:[1,1,1] neg_lo:[1,0,0] neg_hi:[1,0,0]
    v_pk_fma_f32 v[218:219], v[8:9], v[58:59], v[62:63] op_sel:[1,0,0] op_sel_hi:[1,1,1] neg_lo:[1,0,0] neg_hi:[1,0,0]
    v_pk_fma_f32 v[176:177], v[8:9], v[176:177], v[216:217] op_sel:[0,0,0] op_sel_hi:[0,1,1]
    v_pk_fma_f32 v[178:179], v[8:9], v[178:179], v[218:219] op_sel:[0,0,0] op_sel_hi:[0,1,1]
    v_pk_mul_f32 v[216:217], v[176:177], v[176:177]
    v_pk_mul_f32 v[218:219], v[178:179], v[178:179]
    v_pk_fma_f32 v[216:217], v[216:217], v[72:73], v[74:75]
    v_pk_fma_f32 v[218:219], v[218:219], v[72:73], v[74:75]
    v_pk_mul_f32 v[216:217], v[216:217], v[176:177]
    v_pk_mul_f32 v[218:219], v[218:219], v[178:179]
    v_exp_f32 v216, v216
    v_exp_f32 v217, v217
    v_exp_f32 v218, v218
    v_exp_f32 v219, v219
    v_pk_add_f32 v[216:217], v[216:217], v[76:77]
    v_pk_add_f32 v[218:219], v[218:219], v[76:77]
    v_rcp_f32 v216, v216
    v_rcp_f32 v217, v217
    v_rcp_f32 v218, v218
    v_rcp_f32 v219, v219
    v_pk_mul_f32 v[176:177], v[176:177], v[216:217]
    v_pk_mul_f32 v[178:179], v[178:179], v[218:219]
    v_cvt_pk_bf16_f32 v210, v176, v177
    v_cvt_pk_bf16_f32 v211, v178, v179
    s_nop 0
    v_permlane16_swap_b32 v208, v210
    v_permlane16_swap_b32 v209, v211
    s_add_u32 s56, s63, 16384
    buffer_store_dwordx4 v[208:211], v82, s[36:39], s56 offen sc1
    ds_write_b128 v86, v[208:211] offset:0
    v_pk_fma_f32 v[220:221], v[10:11], v[48:49], v[52:53] op_sel:[1,0,0] op_sel_hi:[1,1,1] neg_lo:[1,0,0] neg_hi:[1,0,0]
    v_pk_fma_f32 v[222:223], v[10:11], v[50:51], v[54:55] op_sel:[1,0,0] op_sel_hi:[1,1,1] neg_lo:[1,0,0] neg_hi:[1,0,0]
    v_pk_fma_f32 v[164:165], v[10:11], v[164:165], v[220:221] op_sel:[0,0,0] op_sel_hi:[0,1,1]
    v_pk_fma_f32 v[166:167], v[10:11], v[166:167], v[222:223] op_sel:[0,0,0] op_sel_hi:[0,1,1]
    v_pk_mul_f32 v[220:221], v[164:165], v[164:165]
    v_pk_mul_f32 v[222:223], v[166:167], v[166:167]
    v_pk_fma_f32 v[220:221], v[220:221], v[72:73], v[74:75]
    v_pk_fma_f32 v[222:223], v[222:223], v[72:73], v[74:75]
    v_pk_mul_f32 v[220:221], v[220:221], v[164:165]
    v_pk_mul_f32 v[222:223], v[222:223], v[166:167]
    v_exp_f32 v220, v220
    v_exp_f32 v221, v221
    v_exp_f32 v222, v222
    v_exp_f32 v223, v223
    v_pk_add_f32 v[220:221], v[220:221], v[76:77]
    v_pk_add_f32 v[222:223], v[222:223], v[76:77]
    v_rcp_f32 v220, v220
    v_rcp_f32 v221, v221
    v_rcp_f32 v222, v222
    v_rcp_f32 v223, v223
    v_pk_mul_f32 v[164:165], v[164:165], v[220:221]
    v_pk_mul_f32 v[166:167], v[166:167], v[222:223]
    v_cvt_pk_bf16_f32 v212, v164, v165
    v_cvt_pk_bf16_f32 v213, v166, v167
    v_pk_fma_f32 v[220:221], v[10:11], v[56:57], v[60:61] op_sel:[1,0,0] op_sel_hi:[1,1,1] neg_lo:[1,0,0] neg_hi:[1,0,0]
    v_pk_fma_f32 v[222:223], v[10:11], v[58:59], v[62:63] op_sel:[1,0,0] op_sel_hi:[1,1,1] neg_lo:[1,0,0] neg_hi:[1,0,0]
    v_pk_fma_f32 v[180:181], v[10:11], v[180:181], v[220:221] op_sel:[0,0,0] op_sel_hi:[0,1,1]
    v_pk_fma_f32 v[182:183], v[10:11], v[182:183], v[222:223] op_sel:[0,0,0] op_sel_hi:[0,1,1]
    v_pk_mul_f32 v[220:221], v[180:181], v[180:181]
    v_pk_mul_f32 v[222:223], v[182:183], v[182:183]
    v_pk_fma_f32 v[220:221], v[220:221], v[72:73], v[74:75]
    v_pk_fma_f32 v[222:223], v[222:223], v[72:73], v[74:75]
    v_pk_mul_f32 v[220:221], v[220:221], v[180:181]
    v_pk_mul_f32 v[222:223], v[222:223], v[182:183]
    v_exp_f32 v220, v220
    v_exp_f32 v221, v221
    v_exp_f32 v222, v222
    v_exp_f32 v223, v223
    v_pk_add_f32 v[220:221], v[220:221], v[76:77]
    v_pk_add_f32 v[222:223], v[222:223], v[76:77]
    v_rcp_f32 v220, v220
    v_rcp_f32 v221, v221
    v_rcp_f32 v222, v222
    v_rcp_f32 v223, v223
    v_pk_mul_f32 v[180:181], v[180:181], v[220:221]
    v_pk_mul_f32 v[182:183], v[182:183], v[222:223]
    v_cvt_pk_bf16_f32 v214, v180, v181
    v_cvt_pk_bf16_f32 v215, v182, v183
    s_nop 0
    v_permlane16_swap_b32 v212, v214
    v_permlane16_swap_b32 v213, v215
    s_add_u32 s56, s63, 16640
    buffer_store_dwordx4 v[212:215], v82, s[36:39], s56 offen sc1
    ds_write_b128 v86, v[212:215] offset:256
    v_pk_fma_f32 v[216:217], v[12:13], v[48:49], v[52:53] op_sel:[1,0,0] op_sel_hi:[1,1,1] neg_lo:[1,0,0] neg_hi:[1,0,0]
    v_pk_fma_f32 v[218:219], v[12:13], v[50:51], v[54:55] op_sel:[1,0,0] op_sel_hi:[1,1,1] neg_lo:[1,0,0] neg_hi:[1,0,0]
    v_pk_fma_f32 v[168:169], v[12:13], v[168:169], v[216:217] op_sel:[0,0,0] op_sel_hi:[0,1,1]
    v_pk_fma_f32 v[170:171], v[12:13], v[170:171], v[218:219] op_sel:[0,0,0] op_sel_hi:[0,1,1]
    v_pk_mul_f32 v[216:217], v[168:169], v[168:169]
    v_pk_mul_f32 v[218:219], v[170:171], v[170:171]
    v_pk_fma_f32 v[216:217], v[216:217], v[72:73], v[74:75]
    v_pk_fma_f32 v[218:219], v[218:219], v[72:73], v[74:75]
    v_pk_mul_f32 v[216:217], v[216:217], v[168:169]
    v_pk_mul_f32 v[218:219], v[218:219], v[170:171]
    v_exp_f32 v216, v216
    v_exp_f32 v217, v217
    v_exp_f32 v218, v218
    v_exp_f32 v219, v219
    v_pk_add_f32 v[216:217], v[216:217], v[76:77]
    v_pk_add_f32 v[218:219], v[218:219], v[76:77]
    v_rcp_f32 v216, v216
    v_rcp_f32 v217, v217
    v_rcp_f32 v218, v218
    v_rcp_f32 v219, v219
    v_pk_mul_f32 v[168:169], v[168:169], v[216:217]
    v_pk_mul_f32 v[170:171], v[170:171], v[218:219]
    v_cvt_pk_bf16_f32 v208, v168, v169
    v_cvt_pk_bf16_f32 v209, v170, v171
    v_pk_fma_f32 v[216:217], v[12:13], v[56:57], v[60:61] op_sel:[1,0,0] op_sel_hi:[1,1,1] neg_lo:[1,0,0] neg_hi:[1,0,0]
    v_pk_fma_f32 v[218:219], v[12:13], v[58:59], v[62:63] op_sel:[1,0,0] op_sel_hi:[1,1,1] neg_lo:[1,0,0] neg_hi:[1,0,0]
    v_pk_fma_f32 v[184:185], v[12:13], v[184:185], v[216:217] op_sel:[0,0,0] op_sel_hi:[0,1,1]
    v_pk_fma_f32 v[186:187], v[12:13], v[186:187], v[218:219] op_sel:[0,0,0] op_sel_hi:[0,1,1]
    v_pk_mul_f32 v[216:217], v[184:185], v[184:185]
    v_pk_mul_f32 v[218:219], v[186:187], v[186:187]
    v_pk_fma_f32 v[216:217], v[216:217], v[72:73], v[74:75]
    v_pk_fma_f32 v[218:219], v[218:219], v[72:73], v[74:75]
    v_pk_mul_f32 v[216:217], v[216:217], v[184:185]
    v_pk_mul_f32 v[218:219], v[218:219], v[186:187]
    v_exp_f32 v216, v216
    v_exp_f32 v217, v217
    v_exp_f32 v218, v218
    v_exp_f32 v219, v219
    v_pk_add_f32 v[216:217], v[216:217], v[76:77]
    v_pk_add_f32 v[218:219], v[218:219], v[76:77]
    v_rcp_f32 v216, v216
    v_rcp_f32 v217, v217
    v_rcp_f32 v218, v218
    v_rcp_f32 v219, v219
    v_pk_mul_f32 v[184:185], v[184:185], v[216:217]
    v_pk_mul_f32 v[186:187], v[186:187], v[218:219]
    v_cvt_pk_bf16_f32 v210, v184, v185
    v_cvt_pk_bf16_f32 v211, v186, v187
    s_nop 0
    v_permlane16_swap_b32 v208, v210
    v_permlane16_swap_b32 v209, v211
    s_add_u32 s56, s63, 16896
    buffer_store_dwordx4 v[208:211], v82, s[36:39], s56 offen sc1
    ds_write_b128 v86, v[208:211] offset:512
    v_pk_fma_f32 v[220:221], v[14:15], v[48:49], v[52:53] op_sel:[1,0,0] op_sel_hi:[1,1,1] neg_lo:[1,0,0] neg_hi:[1,0,0]
    v_pk_fma_f32 v[222:223], v[14:15], v[50:51], v[54:55] op_sel:[1,0,0] op_sel_hi:[1,1,1] neg_lo:[1,0,0] neg_hi:[1,0,0]
    v_pk_fma_f32 v[172:173], v[14:15], v[172:173], v[220:221] op_sel:[0,0,0] op_sel_hi:[0,1,1]
    v_pk_fma_f32 v[174:175], v[14:15], v[174:175], v[222:223] op_sel:[0,0,0] op_sel_hi:[0,1,1]
    v_pk_mul_f32 v[220:221], v[172:173], v[172:173]
    v_pk_mul_f32 v[222:223], v[174:175], v[174:175]
    v_pk_fma_f32 v[220:221], v[220:221], v[72:73], v[74:75]
    v_pk_fma_f32 v[222:223], v[222:223], v[72:73], v[74:75]
    v_pk_mul_f32 v[220:221], v[220:221], v[172:173]
    v_pk_mul_f32 v[222:223], v[222:223], v[174:175]
    v_exp_f32 v220, v220
    v_exp_f32 v221, v221
    v_exp_f32 v222, v222
    v_exp_f32 v223, v223
    v_pk_add_f32 v[220:221], v[220:221], v[76:77]
    v_pk_add_f32 v[222:223], v[222:223], v[76:77]
    v_rcp_f32 v220, v220
    v_rcp_f32 v221, v221
    v_rcp_f32 v222, v222
    v_rcp_f32 v223, v223
    v_pk_mul_f32 v[172:173], v[172:173], v[220:221]
    v_pk_mul_f32 v[174:175], v[174:175], v[222:223]
    v_cvt_pk_bf16_f32 v212, v172, v173
    v_cvt_pk_bf16_f32 v213, v174, v175
    v_pk_fma_f32 v[220:221], v[14:15], v[56:57], v[60:61] op_sel:[1,0,0] op_sel_hi:[1,1,1] neg_lo:[1,0,0] neg_hi:[1,0,0]
    v_pk_fma_f32 v[222:223], v[14:15], v[58:59], v[62:63] op_sel:[1,0,0] op_sel_hi:[1,1,1] neg_lo:[1,0,0] neg_hi:[1,0,0]
    v_pk_fma_f32 v[188:189], v[14:15], v[188:189], v[220:221] op_sel:[0,0,0] op_sel_hi:[0,1,1]
    v_pk_fma_f32 v[190:191], v[14:15], v[190:191], v[222:223] op_sel:[0,0,0] op_sel_hi:[0,1,1]
    v_pk_mul_f32 v[220:221], v[188:189], v[188:189]
    v_pk_mul_f32 v[222:223], v[190:191], v[190:191]
    v_pk_fma_f32 v[220:221], v[220:221], v[72:73], v[74:75]
    v_pk_fma_f32 v[222:223], v[222:223], v[72:73], v[74:75]
    v_pk_mul_f32 v[220:221], v[220:221], v[188:189]
    v_pk_mul_f32 v[222:223], v[222:223], v[190:191]
    v_exp_f32 v220, v220
    v_exp_f32 v221, v221
    v_exp_f32 v222, v222
    v_exp_f32 v223, v223
    v_pk_add_f32 v[220:221], v[220:221], v[76:77]
    v_pk_add_f32 v[222:223], v[222:223], v[76:77]
    v_rcp_f32 v220, v220
    v_rcp_f32 v221, v221
    v_rcp_f32 v222, v222
    v_rcp_f32 v223, v223
    v_pk_mul_f32 v[188:189], v[188:189], v[220:221]
    v_pk_mul_f32 v[190:191], v[190:191], v[222:223]
    v_cvt_pk_bf16_f32 v214, v188, v189
    v_cvt_pk_bf16_f32 v215, v190, v191
    s_nop 0
    v_permlane16_swap_b32 v212, v214
    v_permlane16_swap_b32 v213, v215
    s_add_u32 s56, s63, 17152
    buffer_store_dwordx4 v[212:215], v82, s[36:39], s56 offen sc1
    ds_write_b128 v86, v[212:215] offset:768
    v_pk_fma_f32 v[216:217], v[8:9], v[64:65], v[68:69] op_sel:[1,0,0] op_sel_hi:[1,1,1] neg_lo:[1,0,0] neg_hi:[1,0,0]
    v_pk_fma_f32 v[218:219], v[8:9], v[66:67], v[70:71] op_sel:[1,0,0] op_sel_hi:[1,1,1] neg_lo:[1,0,0] neg_hi:[1,0,0]
    v_pk_fma_f32 v[192:193], v[8:9], v[192:193], v[216:217] op_sel:[0,0,0] op_sel_hi:[0,1,1]
    v_pk_fma_f32 v[194:195], v[8:9], v[194:195], v[218:219] op_sel:[0,0,0] op_sel_hi:[0,1,1]
    v_pk_mul_f32 v[216:217], v[192:193], v[192:193]
    v_pk_mul_f32 v[218:219], v[194:195], v[194:195]
    v_pk_fma_f32 v[216:217], v[216:217], v[72:73], v[74:75]
    v_pk_fma_f32 v[218:219], v[218:219], v[72:73], v[74:75]
    v_pk_mul_f32 v[216:217], v[216:217], v[192:193]
    v_pk_mul_f32 v[218:219], v[218:219], v[194:195]
    v_exp_f32 v216, v216
    v_exp_f32 v217, v217
    v_exp_f32 v218, v218
    v_exp_f32 v219, v219
    v_pk_add_f32 v[216:217], v[216:217], v[76:77]
    v_pk_add_f32 v[218:219], v[218:219], v[76:77]
    v_rcp_f32 v216, v216
    v_rcp_f32 v217, v217
    v_rcp_f32 v218, v218
    v_rcp_f32 v219, v219
    v_pk_mul_f32 v[192:193], v[192:193], v[216:217]
    v_pk_mul_f32 v[194:195], v[194:195], v[218:219]
    v_cvt_pk_bf16_f32 v208, v192, v193
    v_cvt_pk_bf16_f32 v209, v194, v195
    v_pk_fma_f32 v[216:217], v[10:11], v[64:65], v[68:69] op_sel:[1,0,0] op_sel_hi:[1,1,1] neg_lo:[1,0,0] neg_hi:[1,0,0]
    v_pk_fma_f32 v[218:219], v[10:11], v[66:67], v[70:71] op_sel:[1,0,0] op_sel_hi:[1,1,1] neg_lo:[1,0,0] neg_hi:[1,0,0]
    v_pk_fma_f32 v[196:197], v[10:11], v[196:197], v[216:217] op_sel:[0,0,0] op_sel_hi:[0,1,1]
    v_pk_fma_f32 v[198:199], v[10:11], v[198:199], v[218:219] op_sel:[0,0,0] op_sel_hi:[0,1,1]
    v_pk_mul_f32 v[216:217], v[196:197], v[196:197]
    v_pk_mul_f32 v[218:219], v[198:199], v[198:199]
    v_pk_fma_f32 v[216:217], v[216:217], v[72:73], v[74:75]
    v_pk_fma_f32 v[218:219], v[218:219], v[72:73], v[74:75]
    v_pk_mul_f32 v[216:217], v[216:217], v[196:197]
    v_pk_mul_f32 v[218:219], v[218:219], v[198:199]
    v_exp_f32 v216, v216
    v_exp_f32 v217, v217
    v_exp_f32 v218, v218
    v_exp_f32 v219, v219
    v_pk_add_f32 v[216:217], v[216:217], v[76:77]
    v_pk_add_f32 v[218:219], v[218:219], v[76:77]
    v_rcp_f32 v216, v216
    v_rcp_f32 v217, v217
    v_rcp_f32 v218, v218
    v_rcp_f32 v219, v219
    v_pk_mul_f32 v[196:197], v[196:197], v[216:217]
    v_pk_mul_f32 v[198:199], v[198:199], v[218:219]
    v_cvt_pk_bf16_f32 v210, v196, v197
    v_cvt_pk_bf16_f32 v211, v198, v199
    s_nop 0
    v_permlane16_swap_b32 v208, v210
    v_permlane16_swap_b32 v209, v211
    s_add_u32 s56, s62, 49152
    buffer_store_dwordx4 v[208:211], v83, s[36:39], s56 offen sc1
    v_pk_fma_f32 v[220:221], v[12:13], v[64:65], v[68:69] op_sel:[1,0,0] op_sel_hi:[1,1,1] neg_lo:[1,0,0] neg_hi:[1,0,0]
    v_pk_fma_f32 v[222:223], v[12:13], v[66:67], v[70:71] op_sel:[1,0,0] op_sel_hi:[1,1,1] neg_lo:[1,0,0] neg_hi:[1,0,0]
    v_pk_fma_f32 v[200:201], v[12:13], v[200:201], v[220:221] op_sel:[0,0,0] op_sel_hi:[0,1,1]
    v_pk_fma_f32 v[202:203], v[12:13], v[202:203], v[222:223] op_sel:[0,0,0] op_sel_hi:[0,1,1]
    v_pk_mul_f32 v[220:221], v[200:201], v[200:201]
    v_pk_mul_f32 v[222:223], v[202:203], v[202:203]
    v_pk_fma_f32 v[220:221], v[220:221], v[72:73], v[74:75]
    v_pk_fma_f32 v[222:223], v[222:223], v[72:73], v[74:75]
    v_pk_mul_f32 v[220:221], v[220:221], v[200:201]
    v_pk_mul_f32 v[222:223], v[222:223], v[202:203]
    v_exp_f32 v220, v220
    v_exp_f32 v221, v221
    v_exp_f32 v222, v222
    v_exp_f32 v223, v223
    v_pk_add_f32 v[220:221], v[220:221], v[76:77]
    v_pk_add_f32 v[222:223], v[222:223], v[76:77]
    v_rcp_f32 v220, v220
    v_rcp_f32 v221, v221
    v_rcp_f32 v222, v222
    v_rcp_f32 v223, v223
    v_pk_mul_f32 v[200:201], v[200:201], v[220:221]
    v_pk_mul_f32 v[202:203], v[202:203], v[222:223]
    v_cvt_pk_bf16_f32 v212, v200, v201
    v_cvt_pk_bf16_f32 v213, v202, v203
    v_pk_fma_f32 v[220:221], v[14:15], v[64:65], v[68:69] op_sel:[1,0,0] op_sel_hi:[1,1,1] neg_lo:[1,0,0] neg_hi:[1,0,0]
    v_pk_fma_f32 v[222:223], v[14:15], v[66:67], v[70:71] op_sel:[1,0,0] op_sel_hi:[1,1,1] neg_lo:[1,0,0] neg_hi:[1,0,0]
    v_pk_fma_f32 v[204:205], v[14:15], v[204:205], v[220:221] op_sel:[0,0,0] op_sel_hi:[0,1,1]
    v_pk_fma_f32 v[206:207], v[14:15], v[206:207], v[222:223] op_sel:[0,0,0] op_sel_hi:[0,1,1]
    v_pk_mul_f32 v[220:221], v[204:205], v[204:205]
    v_pk_mul_f32 v[222:223], v[206:207], v[206:207]
    v_pk_fma_f32 v[220:221], v[220:221], v[72:73], v[74:75]
    v_pk_fma_f32 v[222:223], v[222:223], v[72:73], v[74:75]
    v_pk_mul_f32 v[220:221], v[220:221], v[204:205]
    v_pk_mul_f32 v[222:223], v[222:223], v[206:207]
    v_exp_f32 v220, v220
    v_exp_f32 v221, v221
    v_exp_f32 v222, v222
    v_exp_f32 v223, v223
    v_pk_add_f32 v[220:221], v[220:221], v[76:77]
    v_pk_add_f32 v[222:223], v[222:223], v[76:77]
    v_rcp_f32 v220, v220
    v_rcp_f32 v221, v221
    v_rcp_f32 v222, v222
    v_rcp_f32 v223, v223
    v_pk_mul_f32 v[204:205], v[204:205], v[220:221]
    v_pk_mul_f32 v[206:207], v[206:207], v[222:223]
    v_cvt_pk_bf16_f32 v214, v204, v205
    v_cvt_pk_bf16_f32 v215, v206, v207
    s_nop 0
    v_permlane16_swap_b32 v212, v214
    v_permlane16_swap_b32 v213, v215
    s_add_u32 s56, s62, 49664
    buffer_store_dwordx4 v[212:215], v83, s[36:39], s56 offen sc1
L_g1end_36:
    s_cmp_lt_u32 s52, 4
    s_cbranch_scc1 L_g2comp_61
    s_and_b32 s56, s53, 1
    s_lshl_b32 s56, s56, 3
    s_and_b32 s57, s54, 7
    s_add_u32 s60, s56, s57
    s_lshr_b32 s56, s53, 1
    s_lshl_b32 s56, s56, 2
    s_lshr_b32 s57, s54, 3
    s_add_u32 s56, s56, s57
    s_and_b32 s61, s56, 7
    s_lshr_b32 s69, s56, 3
    s_mov_b32 s44, s26
    s_mov_b32 s45, s27
    s_mov_b32 s46, 7340032
    s_mov_b32 s47, 0x20000
    s_sub_u32 s58, s52, 4
    v_lshrrev_b32 v13, 4, v0
    v_and_b32 v14, 15, v0
    v_lshrrev_b32 v15, 1, v14
    v_and_b32 v16, 1, v14
    v_xor_b32 v15, v15, v13
    v_lshlrev_b32 v17, 11, v13
    v_lshl_add_u32 v17, v16, 4, v17
    s_lshl_b32 s59, s61, 8
    v_add_u32 v17, s59, v17
    s_mov_b32 s56, 0
    v_xor_b32 v18, 0, v15
    v_lshrrev_b32 v19, 2, v18
    v_mul_lo_u32 v19, v19, s56
    v_lshl_add_u32 v18, v18, 5, v17
    v_add_u32 v18, v18, v19
    v_add_u32 v6, 0, v18
    v_xor_b32 v18, 0, v15
    v_lshrrev_b32 v19, 2, v18
    v_mul_lo_u32 v19, v19, s56
    v_lshl_add_u32 v18, v18, 5, v17
    v_add_u32 v18, v18, v19
    v_add_u32 v7, 8192, v18
    v_xor_b32 v18, 4, v15
    v_lshrrev_b32 v19, 2, v18
    v_mul_lo_u32 v19, v19, s56
    v_lshl_add_u32 v18, v18, 5, v17
    v_add_u32 v18, v18, v19
    v_add_u32 v8, 16384, v18
    v_xor_b32 v18, 4, v15
    v_lshrrev_b32 v19, 2, v18
    v_mul_lo_u32 v19, v19, s56
    v_lshl_add_u32 v18, v18, 5, v17
    v_add_u32 v18, v18, v19
    v_add_u32 v9, 24576, v18
    v_lshlrev_b32 v2, 4, v0
    s_lshl_b32 s62, s58, 12
    s_add_u32 s63, s62, 16384
    s_mov_b32 s85, s61
    s_lshl_b32 s86, s69, 3
    s_add_u32 s86, s86, s85
    s_mul_i32 s86, s86, 224
    s_lshr_b32 s84, s58, 1
    s_and_b32 s87, s58, 1
    s_lshl_b32 s56, s84, 1
    s_add_u32 s56, s56, s87
    s_cmp_ge_u32 s84, 3
    s_addc_u32 s56, s56, 0
    s_mul_i32 s57, s87, 7
    s_add_u32 s57, s57, 6
    s_cmp_eq_u32 s84, 6
    s_cselect_b32 s56, s57, s56
    s_lshl_b32 s56, s56, 4
    s_add_u32 s56, s56, s86
    s_lshl_b32 s65, s56, 11
    s_mul_i32 s90, s60, 112
    s_mul_i32 s56, s69, 56
    s_add_u32 s90, s90, s56
    s_lshl_b32 s90, s90, 13
    s_lshl_b32 s56, s87, 12
    s_add_u32 s90, s90, s56
    s_add_u32 s90, s90, 13631488
    s_mov_b32 s64, 0
    s_add_u32 m0, s64, s63
    s_nop 0
    buffer_load_dwordx4 v6, s[44:47], s65 offen lds
    s_add_u32 m0, m0, 1024
    s_nop 0
    buffer_load_dwordx4 v7, s[44:47], s65 offen lds
    s_add_u32 m0, m0, 1024
    s_nop 0
    buffer_load_dwordx4 v8, s[44:47], s65 offen lds
    s_add_u32 m0, m0, 1024
    s_nop 0
    buffer_load_dwordx4 v9, s[44:47], s65 offen lds
    s_add_u32 s84, s84, 2
    s_lshl_b32 s56, s69, 3
    s_add_u32 s56, s56, s85
    s_mul_i32 s86, s56, 224
    s_lshl_b32 s56, s84, 1
    s_add_u32 s56, s56, s87
    s_cmp_ge_u32 s84, 3
    s_addc_u32 s56, s56, 0
    s_mul_i32 s57, s87, 7
    s_add_u32 s57, s57, 6
    s_cmp_eq_u32 s84, 6
    s_cselect_b32 s56, s57, s56
    s_lshl_b32 s56, s56, 4
    s_add_u32 s56, s56, s86
    s_lshl_b32 s65, s56, 11
    s_add_u32 s64, s64, 32768
    s_add_u32 m0, s64, s63
    s_nop 0
    buffer_load_dwordx4 v6, s[44:47], s65 offen lds
    s_add_u32 m0, m0, 1024
    s_nop 0
    buffer_load_dwordx4 v7, s[44:47], s65 offen lds
    s_add_u32 m0, m0, 1024
    s_nop 0
    buffer_load_dwordx4 v8, s[44:47], s65 offen lds
    s_add_u32 m0, m0, 1024
    s_nop 0
    buffer_load_dwordx4 v9, s[44:47], s65 offen lds
    s_add_u32 s84, s84, 2
    s_lshl_b32 s56, s69, 3
    s_add_u32 s56, s56, s85
    s_mul_i32 s86, s56, 224
    s_lshl_b32 s56, s84, 1
    s_add_u32 s56, s56, s87
    s_cmp_ge_u32 s84, 3
    s_addc_u32 s56, s56, 0
    s_mul_i32 s57, s87, 7
    s_add_u32 s57, s57, 6
    s_cmp_eq_u32 s84, 6
    s_cselect_b32 s56, s57, s56
    s_lshl_b32 s56, s56, 4
    s_add_u32 s56, s56, s86
    s_lshl_b32 s65, s56, 11
    s_add_u32 s64, s64, 32768
    s_add_u32 m0, s64, s63
    s_nop 0
    buffer_load_dwordx4 v6, s[44:47], s65 offen lds
    s_add_u32 m0, m0, 1024
    s_nop 0
    buffer_load_dwordx4 v7, s[44:47], s65 offen lds
    s_add_u32 m0, m0, 1024
    s_nop 0
    buffer_load_dwordx4 v8, s[44:47], s65 offen lds
    s_add_u32 m0, m0, 1024
    s_nop 0
    buffer_load_dwordx4 v9, s[44:47], s65 offen lds
    s_add_u32 s64, s64, 32768
    s_lshr_b32 s91, s58, 1
    s_sub_u32 s91, s91, 2
    s_add_u32 s91, s91, 2
    s_mul_i32 s56, s61, 7
    s_cmp_ge_u32 s91, s56
    s_cselect_b32 s56, 6, 0
    s_add_u32 s56, s56, s91
    s_mul_i32 s85, s56, 9363
    s_lshr_b32 s85, s85, 16
    s_mul_i32 s57, s85, 7
    s_sub_u32 s84, s56, s57
    s_lshl_b32 s56, s69, 3
    s_add_u32 s56, s56, s85
    s_mul_i32 s86, s56, 224
    s_lshl_b32 s56, s84, 1
    s_add_u32 s56, s56, s87
    s_cmp_ge_u32 s84, 3
    s_addc_u32 s56, s56, 0
    s_mul_i32 s57, s87, 7
    s_add_u32 s57, s57, 6
    s_cmp_eq_u32 s84, 6
    s_cselect_b32 s56, s57, s56
    s_lshl_b32 s56, s56, 4
    s_add_u32 s56, s56, s86
    s_lshl_b32 s65, s56, 11
    s_waitcnt vmcnt(8)
    s_barrier
    s_cmp_eq_u32 s52, 4
    s_cbranch_scc0 L_g2pub_63
    s_add_u32 s56, s55, 5
    v_mov_b32 v254, s56
    s_lshl_b32 s57, s53, 10
    s_lshr_b32 s56, s54, 2
    s_lshl_b32 s56, s56, 7
    s_add_u32 s57, s57, s56
    s_and_b32 s56, s54, 3
    s_lshl_b32 s56, s56, 2
    s_add_u32 s57, s57, s56
    v_mov_b32 v255, s57
    s_mov_b64 exec, 1
    buffer_store_dword v254, v255, s[36:39], 0 offen sc1
    s_mov_b64 exec, -1
L_g2pub_63:
    s_waitcnt vmcnt(4)
    s_barrier
    s_waitcnt vmcnt(0)
    s_barrier
    v_and_b32 v20, 7, v0
    s_lshl_b32 s56, s69, 3
    v_add_u32 v21, s56, v20
    v_mov_b32 v20, s60
    v_lshrrev_b32 v40, 3, v20
    v_lshrrev_b32 v26, 2, v21
    v_lshl_add_u32 v40, v26, 1, v40
    v_and_b32 v26, 7, v20
    v_lshl_add_u32 v40, v26, 3, v40
    v_and_b32 v26, 3, v21
    v_lshl_add_u32 v40, v26, 6, v40
    s_xor_b32 s56, s2, 4
    v_mov_b32 v20, s56
    v_bfe_u32 v21, v0, 3, 1
    v_cmp_eq_u32 vcc, 1, v21
    s_nop 1
    v_cndmask_b32 v40, v40, v20, vcc
    v_and_b32 v26, 7, v40
    v_lshlrev_b32 v26, 10, v26
    v_lshrrev_b32 v27, 5, v40
    v_lshl_add_u32 v26, v27, 7, v26
    v_bfe_u32 v40, v40, 3, 2
    v_lshl_add_u32 v40, v40, 2, v26
    s_mov_b64 exec, 0xffff
    s_add_u32 s56, s55, 5
    s_mov_b32 s57, 0x200000
L_pa_64:
    buffer_load_dword v41, v40, s[36:39], 0 offen sc1
    s_sub_u32 s57, s57, 1
    s_cmp_eq_u32 s57, 0
    s_cbranch_scc1 L_pax_65
    s_waitcnt vmcnt(0)
    v_subrev_u32 v41, s56, v41
    v_cmp_le_u32 vcc, 16, v41
    s_cbranch_vccnz L_pa_64
L_pax_65:
    s_waitcnt vmcnt(0)
    s_mov_b64 exec, -1
    s_mul_i32 s56, s85, 7
    s_add_u32 s56, s56, s84
    s_lshl_b32 s56, s56, 13
    s_add_u32 s66, s90, s56
    s_add_u32 m0, s64, s62
    s_nop 0
    buffer_load_dwordx4 v2, s[36:39], s66 offen sc1 lds
    s_add_u32 m0, m0, 1024
    s_add_u32 s66, s66, 1024
    buffer_load_dwordx4 v2, s[36:39], s66 offen sc1 lds
    s_add_u32 m0, m0, 1024
    s_add_u32 s66, s66, 1024
    buffer_load_dwordx4 v2, s[36:39], s66 offen sc1 lds
    s_add_u32 m0, m0, 1024
    s_add_u32 s66, s66, 1024
    buffer_load_dwordx4 v2, s[36:39], s66 offen sc1 lds
    s_add_u32 m0, s64, s63
    s_nop 0
    buffer_load_dwordx4 v6, s[44:47], s65 offen lds
    s_add_u32 m0, m0, 1024
    s_nop 0
    buffer_load_dwordx4 v7, s[44:47], s65 offen lds
    s_add_u32 m0, m0, 1024
    s_nop 0
    buffer_load_dwordx4 v8, s[44:47], s65 offen lds
    s_add_u32 m0, m0, 1024
    s_nop 0
    buffer_load_dwordx4 v9, s[44:47], s65 offen lds
    s_add_u32 s91, s91, 2
    s_mul_i32 s56, s61, 7
    s_cmp_ge_u32 s91, s56
    s_cselect_b32 s56, 6, 0
    s_add_u32 s56, s56, s91
    s_mul_i32 s85, s56, 9363
    s_lshr_b32 s85, s85, 16
    s_mul_i32 s57, s85, 7
    s_sub_u32 s84, s56, s57
    s_lshl_b32 s56, s69, 3
    s_add_u32 s56, s56, s85
    s_mul_i32 s86, s56, 224
    s_lshl_b32 s56, s84, 1
    s_add_u32 s56, s56, s87
    s_cmp_ge_u32 s84, 3
    s_addc_u32 s56, s56, 0
    s_mul_i32 s57, s87, 7
    s_add_u32 s57, s57, 6
    s_cmp_eq_u32 s84, 6
    s_cselect_b32 s56, s57, s56
    s_lshl_b32 s56, s56, 4
    s_add_u32 s56, s56, s86
    s_lshl_b32 s65, s56, 11
    s_add_u32 s64, s64, 32768
    s_cmp_eq_u32 s64, 163840
    s_cselect_b32 s64, 0, s64
    s_mul_i32 s56, s85, 7
    s_add_u32 s56, s56, s84
    s_lshl_b32 s56, s56, 13
    s_add_u32 s66, s90, s56
    s_add_u32 m0, s64, s62
    s_nop 0
    buffer_load_dwordx4 v2, s[36:39], s66 offen sc1 lds
    s_add_u32 m0, m0, 1024
    s_add_u32 s66, s66, 1024
    buffer_load_dwordx4 v2, s[36:39], s66 offen sc1 lds
    s_add_u32 m0, m0, 1024
    s_add_u32 s66, s66, 1024
    buffer_load_dwordx4 v2, s[36:39], s66 offen sc1 lds
    s_add_u32 m0, m0, 1024
    s_add_u32 s66, s66, 1024
    buffer_load_dwordx4 v2, s[36:39], s66 offen sc1 lds
    s_add_u32 m0, s64, s63
    s_nop 0
    buffer_load_dwordx4 v6, s[44:47], s65 offen lds
    s_add_u32 m0, m0, 1024
    s_nop 0
    buffer_load_dwordx4 v7, s[44:47], s65 offen lds
    s_add_u32 m0, m0, 1024
    s_nop 0
    buffer_load_dwordx4 v8, s[44:47], s65 offen lds
    s_add_u32 m0, m0, 1024
    s_nop 0
    buffer_load_dwordx4 v9, s[44:47], s65 offen lds
    s_add_u32 s91, s91, 2
    s_mul_i32 s56, s61, 7
    s_cmp_ge_u32 s91, s56
    s_cselect_b32 s56, 6, 0
    s_add_u32 s56, s56, s91
    s_mul_i32 s85, s56, 9363
    s_lshr_b32 s85, s85, 16
    s_mul_i32 s57, s85, 7
    s_sub_u32 s84, s56, s57
    s_lshl_b32 s56, s69, 3
    s_add_u32 s56, s56, s85
    s_mul_i32 s86, s56, 224
    s_lshl_b32 s56, s84, 1
    s_add_u32 s56, s56, s87
    s_cmp_ge_u32 s84, 3
    s_addc_u32 s56, s56, 0
    s_mul_i32 s57, s87, 7
    s_add_u32 s57, s57, 6
    s_cmp_eq_u32 s84, 6
    s_cselect_b32 s56, s57, s56
    s_lshl_b32 s56, s56, 4
    s_add_u32 s56, s56, s86
    s_lshl_b32 s65, s56, 11
    s_add_u32 s64, s64, 32768
    s_cmp_eq_u32 s64, 163840
    s_cselect_b32 s64, 0, s64
    s_waitcnt vmcnt(8)
    s_barrier
    s_mul_i32 s56, s85, 7
    s_add_u32 s56, s56, s84
    s_lshl_b32 s56, s56, 13
    s_add_u32 s66, s90, s56
    s_add_u32 m0, s64, s62
    s_nop 0
    buffer_load_dwordx4 v2, s[36:39], s66 offen sc1 lds
    s_add_u32 m0, m0, 1024
    s_add_u32 s66, s66, 1024
    buffer_load_dwordx4 v2, s[36:39], s66 offen sc1 lds
    s_add_u32 m0, m0, 1024
    s_add_u32 s66, s66, 1024
    buffer_load_dwordx4 v2, s[36:39], s66 offen sc1 lds
    s_add_u32 m0, m0, 1024
    s_add_u32 s66, s66, 1024
    buffer_load_dwordx4 v2, s[36:39], s66 offen sc1 lds
    s_add_u32 m0, s64, s63
    s_nop 0
    buffer_load_dwordx4 v6, s[44:47], s65 offen lds
    s_add_u32 m0, m0, 1024
    s_nop 0
    buffer_load_dwordx4 v7, s[44:47], s65 offen lds
    s_add_u32 m0, m0, 1024
    s_nop 0
    buffer_load_dwordx4 v8, s[44:47], s65 offen lds
    s_add_u32 m0, m0, 1024
    s_nop 0
    buffer_load_dwordx4 v9, s[44:47], s65 offen lds
    s_add_u32 s91, s91, 2
    s_mul_i32 s56, s61, 7
    s_cmp_ge_u32 s91, s56
    s_cselect_b32 s56, 6, 0
    s_add_u32 s56, s56, s91
    s_mul_i32 s85, s56, 9363
    s_lshr_b32 s85, s85, 16
    s_mul_i32 s57, s85, 7
    s_sub_u32 s84, s56, s57
    s_lshl_b32 s56, s69, 3
    s_add_u32 s56, s56, s85
    s_mul_i32 s86, s56, 224
    s_lshl_b32 s56, s84, 1
    s_add_u32 s56, s56, s87
    s_cmp_ge_u32 s84, 3
    s_addc_u32 s56, s56, 0
    s_mul_i32 s57, s87, 7
    s_add_u32 s57, s57, 6
    s_cmp_eq_u32 s84, 6
    s_cselect_b32 s56, s57, s56
    s_lshl_b32 s56, s56, 4
    s_add_u32 s56, s56, s86
    s_lshl_b32 s65, s56, 11
    s_add_u32 s64, s64, 32768
    s_cmp_eq_u32 s64, 163840
    s_cselect_b32 s64, 0, s64
    s_mul_i32 s56, s85, 7
    s_add_u32 s56, s56, s84
    s_lshl_b32 s56, s56, 13
    s_add_u32 s66, s90, s56
    s_add_u32 m0, s64, s62
    s_nop 0
    buffer_load_dwordx4 v2, s[36:39], s66 offen sc1 lds
    s_add_u32 m0, m0, 1024
    s_add_u32 s66, s66, 1024
    buffer_load_dwordx4 v2, s[36:39], s66 offen sc1 lds
    s_add_u32 m0, m0, 1024
    s_add_u32 s66, s66, 1024
    buffer_load_dwordx4 v2, s[36:39], s66 offen sc1 lds
    s_add_u32 m0, m0, 1024
    s_add_u32 s66, s66, 1024
    buffer_load_dwordx4 v2, s[36:39], s66 offen sc1 lds
    s_add_u32 m0, s64, s63
    s_nop 0
    buffer_load_dwordx4 v6, s[44:47], s65 offen lds
    s_add_u32 m0, m0, 1024
    s_nop 0
    buffer_load_dwordx4 v7, s[44:47], s65 offen lds
    s_add_u32 m0, m0, 1024
    s_nop 0
    buffer_load_dwordx4 v8, s[44:47], s65 offen lds
    s_add_u32 m0, m0, 1024
    s_nop 0
    buffer_load_dwordx4 v9, s[44:47], s65 offen lds
    s_add_u32 s91, s91, 2
    s_mul_i32 s56, s61, 7
    s_cmp_ge_u32 s91, s56
    s_cselect_b32 s56, 6, 0
    s_add_u32 s56, s56, s91
    s_mul_i32 s85, s56, 9363
    s_lshr_b32 s85, s85, 16
    s_mul_i32 s57, s85, 7
    s_sub_u32 s84, s56, s57
    s_lshl_b32 s56, s69, 3
    s_add_u32 s56, s56, s85
    s_mul_i32 s86, s56, 224
    s_lshl_b32 s56, s84, 1
    s_add_u32 s56, s56, s87
    s_cmp_ge_u32 s84, 3
    s_addc_u32 s56, s56, 0
    s_mul_i32 s57, s87, 7
    s_add_u32 s57, s57, 6
    s_cmp_eq_u32 s84, 6
    s_cselect_b32 s56, s57, s56
    s_lshl_b32 s56, s56, 4
    s_add_u32 s56, s56, s86
    s_lshl_b32 s65, s56, 11
    s_add_u32 s64, s64, 32768
    s_cmp_eq_u32 s64, 163840
    s_cselect_b32 s64, 0, s64
    s_waitcnt vmcnt(16)
    s_barrier
    s_mul_i32 s56, s85, 7
    s_add_u32 s56, s56, s84
    s_lshl_b32 s56, s56, 13
    s_add_u32 s66, s90, s56
    s_add_u32 m0, s64, s62
    s_nop 0
    buffer_load_dwordx4 v2, s[36:39], s66 offen sc1 lds
    s_add_u32 m0, m0, 1024
    s_add_u32 s66, s66, 1024
    buffer_load_dwordx4 v2, s[36:39], s66 offen sc1 lds
    s_add_u32 m0, m0, 1024
    s_add_u32 s66, s66, 1024
    buffer_load_dwordx4 v2, s[36:39], s66 offen sc1 lds
    s_add_u32 m0, m0, 1024
    s_add_u32 s66, s66, 1024
    buffer_load_dwordx4 v2, s[36:39], s66 offen sc1 lds
    s_add_u32 m0, s64, s63
    s_nop 0
    buffer_load_dwordx4 v6, s[44:47], s65 offen lds
    s_add_u32 m0, m0, 1024
    s_nop 0
    buffer_load_dwordx4 v7, s[44:47], s65 offen lds
    s_add_u32 m0, m0, 1024
    s_nop 0
    buffer_load_dwordx4 v8, s[44:47], s65 offen lds
    s_add_u32 m0, m0, 1024
    s_nop 0
    buffer_load_dwordx4 v9, s[44:47], s65 offen lds
    s_add_u32 s91, s91, 2
    s_mul_i32 s56, s61, 7
    s_cmp_ge_u32 s91, s56
    s_cselect_b32 s56, 6, 0
    s_add_u32 s56, s56, s91
    s_mul_i32 s85, s56, 9363
    s_lshr_b32 s85, s85, 16
    s_mul_i32 s57, s85, 7
    s_sub_u32 s84, s56, s57
    s_lshl_b32 s56, s69, 3
    s_add_u32 s56, s56, s85
    s_mul_i32 s86, s56, 224
    s_lshl_b32 s56, s84, 1
    s_add_u32 s56, s56, s87
    s_cmp_ge_u32 s84, 3
    s_addc_u32 s56, s56, 0
    s_mul_i32 s57, s87, 7
    s_add_u32 s57, s57, 6
    s_cmp_eq_u32 s84, 6
    s_cselect_b32 s56, s57, s56
    s_lshl_b32 s56, s56, 4
    s_add_u32 s56, s56, s86
    s_lshl_b32 s65, s56, 11
    s_add_u32 s64, s64, 32768
    s_cmp_eq_u32 s64, 163840
    s_cselect_b32 s64, 0, s64
    s_mul_i32 s56, s85, 7
    s_add_u32 s56, s56, s84
    s_lshl_b32 s56, s56, 13
    s_add_u32 s66, s90, s56
    s_add_u32 m0, s64, s62
    s_nop 0
    buffer_load_dwordx4 v2, s[36:39], s66 offen sc1 lds
    s_add_u32 m0, m0, 1024
    s_add_u32 s66, s66, 1024
    buffer_load_dwordx4 v2, s[36:39], s66 offen sc1 lds
    s_add_u32 m0, m0, 1024
    s_add_u32 s66, s66, 1024
    buffer_load_dwordx4 v2, s[36:39], s66 offen sc1 lds
    s_add_u32 m0, m0, 1024
    s_add_u32 s66, s66, 1024
    buffer_load_dwordx4 v2, s[36:39], s66 offen sc1 lds
    s_add_u32 m0, s64, s63
    s_nop 0
    buffer_load_dwordx4 v6, s[44:47], s65 offen lds
    s_add_u32 m0, m0, 1024
    s_nop 0
    buffer_load_dwordx4 v7, s[44:47], s65 offen lds
    s_add_u32 m0, m0, 1024
    s_nop 0
    buffer_load_dwordx4 v8, s[44:47], s65 offen lds
    s_add_u32 m0, m0, 1024
    s_nop 0
    buffer_load_dwordx4 v9, s[44:47], s65 offen lds
    s_add_u32 s91, s91, 2
    s_mul_i32 s56, s61, 7
    s_cmp_ge_u32 s91, s56
    s_cselect_b32 s56, 6, 0
    s_add_u32 s56, s56, s91
    s_mul_i32 s85, s56, 9363
    s_lshr_b32 s85, s85, 16
    s_mul_i32 s57, s85, 7
    s_sub_u32 s84, s56, s57
    s_lshl_b32 s56, s69, 3
    s_add_u32 s56, s56, s85
    s_mul_i32 s86, s56, 224
    s_lshl_b32 s56, s84, 1
    s_add_u32 s56, s56, s87
    s_cmp_ge_u32 s84, 3
    s_addc_u32 s56, s56, 0
    s_mul_i32 s57, s87, 7
    s_add_u32 s57, s57, 6
    s_cmp_eq_u32 s84, 6
    s_cselect_b32 s56, s57, s56
    s_lshl_b32 s56, s56, 4
    s_add_u32 s56, s56, s86
    s_lshl_b32 s65, s56, 11
    s_add_u32 s64, s64, 32768
    s_cmp_eq_u32 s64, 163840
    s_cselect_b32 s64, 0, s64
    s_waitcnt vmcnt(24)
    s_barrier
    s_mov_b32 s67, 5
L_g2l_66:
    s_cmp_ge_u32 s67, 24
    s_cbranch_scc1 L_g2lw_67
    s_mul_i32 s56, s85, 7
    s_add_u32 s56, s56, s84
    s_lshl_b32 s56, s56, 13
    s_add_u32 s66, s90, s56
    s_add_u32 m0, s64, s62
    s_nop 0
    buffer_load_dwordx4 v2, s[36:39], s66 offen sc1 lds
    s_add_u32 m0, m0, 1024
    s_add_u32 s66, s66, 1024
    buffer_load_dwordx4 v2, s[36:39], s66 offen sc1 lds
    s_add_u32 m0, m0, 1024
    s_add_u32 s66, s66, 1024
    buffer_load_dwordx4 v2, s[36:39], s66 offen sc1 lds
    s_add_u32 m0, m0, 1024
    s_add_u32 s66, s66, 1024
    buffer_load_dwordx4 v2, s[36:39], s66 offen sc1 lds
    s_add_u32 m0, s64, s63
    s_nop 0
    buffer_load_dwordx4 v6, s[44:47], s65 offen lds
    s_add_u32 m0, m0, 1024
    s_nop 0
    buffer_load_dwordx4 v7, s[44:47], s65 offen lds
    s_add_u32 m0, m0, 1024
    s_nop 0
    buffer_load_dwordx4 v8, s[44:47], s65 offen lds
    s_add_u32 m0, m0, 1024
    s_nop 0
    buffer_load_dwordx4 v9, s[44:47], s65 offen lds
    s_add_u32 s91, s91, 2
    s_mul_i32 s56, s61, 7
    s_cmp_ge_u32 s91, s56
    s_cselect_b32 s56, 6, 0
    s_add_u32 s56, s56, s91
    s_mul_i32 s85, s56, 9363
    s_lshr_b32 s85, s85, 16
    s_mul_i32 s57, s85, 7
    s_sub_u32 s84, s56, s57
    s_lshl_b32 s56, s69, 3
    s_add_u32 s56, s56, s85
    s_mul_i32 s86, s56, 224
    s_lshl_b32 s56, s84, 1
    s_add_u32 s56, s56, s87
    s_cmp_ge_u32 s84, 3
    s_addc_u32 s56, s56, 0
    s_mul_i32 s57, s87, 7
    s_add_u32 s57, s57, 6
    s_cmp_eq_u32 s84, 6
    s_cselect_b32 s56, s57, s56
    s_lshl_b32 s56, s56, 4
    s_add_u32 s56, s56, s86
    s_lshl_b32 s65, s56, 11
    s_add_u32 s64, s64, 32768
    s_cmp_eq_u32 s64, 163840
    s_cselect_b32 s64, 0, s64
    s_waitcnt vmcnt(24)
    s_branch L_g2lb_68
L_g2lw_67:
    s_cmp_eq_u32 s67, 24
    s_cbranch_scc0 L_g2lw1_69
    v_lshrrev_b32 v20, 2, v0
    s_lshl_b32 s56, s58, 5
    v_add_u32 v20, s56, v20
    v_lshlrev_b32 v20, 8, v20
    v_and_b32 v21, 3, v0
    v_lshl_add_u32 v20, v21, 4, v20
    s_lshr_b32 s57, s58, 1
    s_mov_b32 s59, s61
    s_lshl_b32 s56, s60, 18
    s_lshl_b32 s57, s59, 15
    s_add_u32 s56, s56, s57
    s_lshl_b32 s57, s69, 6
    s_add_u32 s56, s56, s57
    s_add_u32 s56, s56, 9437184
    s_add_u32 s57, s56, 0
    s_lshl_b32 s59, s58, 11
    s_add_u32 m0, s59, 98304
    s_nop 0
    buffer_load_dwordx4 v20, s[36:39], s57 offen sc1 lds
    s_add_u32 s57, s56, 4096
    s_lshl_b32 s59, s58, 11
    s_add_u32 m0, s59, 99328
    s_nop 0
    buffer_load_dwordx4 v20, s[36:39], s57 offen sc1 lds
    s_add_u32 s57, s56, 128
    s_lshl_b32 s59, s58, 11
    s_add_u32 m0, s59, 106496
    s_nop 0
    buffer_load_dwordx4 v20, s[36:39], s57 offen sc1 lds
    s_add_u32 s57, s56, 4224
    s_lshl_b32 s59, s58, 11
    s_add_u32 m0, s59, 107520
    s_nop 0
    buffer_load_dwordx4 v20, s[36:39], s57 offen sc1 lds
    s_waitcnt vmcnt(20)
    s_branch L_g2lb_68
L_g2lw1_69:
    s_cmp_eq_u32 s67, 25
    s_cbranch_scc0 L_g2w_70
    s_waitcnt vmcnt(12)
    s_branch L_g2lb_68
L_g2w_70:
    s_cmp_eq_u32 s67, 26
    s_cbranch_scc0 L_g2w_71
    s_waitcnt vmcnt(4)
    s_branch L_g2lb_68
L_g2w_71:
    s_waitcnt vmcnt(0)
L_g2lb_68:
    s_barrier
    s_add_u32 s67, s67, 1
    s_cmp_lt_u32 s67, 28
    s_cbranch_scc1 L_g2l_66
    s_cmp_lg_u32 s52, 4
    s_cbranch_scc1 L_g2ep_72
    s_cmp_lg_u32 s2, 0
    s_cbranch_scc1 L_g2ep_72
    v_mov_b32 v254, s55
    v_mov_b32 v255, 32768
    s_mov_b64 exec, 1
    buffer_store_dword v254, v255, s[36:39], 0 offen sc1
    s_mov_b64 exec, -1
L_g2ep_72:
    s_branch L_g2end_62
L_g2comp_61:
    s_and_b32 s56, s53, 1
    s_lshl_b32 s56, s56, 3
    s_and_b32 s57, s54, 7
    s_add_u32 s60, s56, s57
    s_lshr_b32 s56, s53, 1
    s_lshl_b32 s56, s56, 2
    s_lshr_b32 s57, s54, 3
    s_add_u32 s56, s56, s57
    s_and_b32 s61, s56, 7
    s_lshr_b32 s69, s56, 3
    s_lshr_b32 s58, s52, 1
    s_and_b32 s59, s52, 1
    v_lshrrev_b32 v13, 4, v0
    v_and_b32 v14, 15, v0
    v_lshrrev_b32 v15, 2, v14
    v_and_b32 v16, 3, v14
    v_lshl_add_u32 v17, v13, 3, v15
    v_and_b32 v18, 1, v13
    v_lshl_or_b32 v20, v18, 2, v15
    v_lshlrev_b32 v21, 8, v17
    v_lshl_add_u32 v21, v16, 3, v21
    v_add_u32 v21, 16384, v21
    s_lshl_b32 s57, s58, 2
    s_add_u32 s56, s57, 0
    v_xor_b32 v22, s56, v20
    v_lshl_add_u32 v2, v22, 5, v21
    s_add_u32 s56, s57, 1
    v_xor_b32 v22, s56, v20
    v_lshl_add_u32 v3, v22, 5, v21
    s_add_u32 s56, s57, 2
    v_xor_b32 v22, s56, v20
    v_lshl_add_u32 v4, v22, 5, v21
    s_add_u32 s56, s57, 3
    v_xor_b32 v22, s56, v20
    v_lshl_add_u32 v5, v22, 5, v21
    v_lshlrev_b32 v22, 11, v13
    v_lshl_add_u32 v22, v14, 4, v22
    s_lshl_b32 s56, s59, 10
    v_add_u32 v6, s56, v22
    s_waitcnt vmcnt(0) lgkmcnt(0)
    s_barrier
    s_mov_b32 s64, 0
    s_mov_b32 s62, 32768
    s_mov_b32 s63, 4294836224
    ds_read_b128 v[24:27], v6 offset:0
    ds_read_b128 v[28:31], v6 offset:256
    ds_read_b128 v[32:35], v6 offset:512
    ds_read_b128 v[36:39], v6 offset:768
    ds_read_b64_tr_b16 v[8:9], v2 offset:0
    ds_read_b64_tr_b16 v[10:11], v2 offset:1024
    ds_read_b64_tr_b16 v[12:13], v3 offset:0
    ds_read_b64_tr_b16 v[14:15], v3 offset:1024
    ds_read_b64_tr_b16 v[16:17], v4 offset:0
    ds_read_b64_tr_b16 v[18:19], v4 offset:1024
    ds_read_b64_tr_b16 v[20:21], v5 offset:0
    ds_read_b64_tr_b16 v[22:23], v5 offset:1024
    s_add_u32 s64, s64, 1
    s_cmp_eq_u32 s64, 5
    s_cselect_b32 s65, s63, s62
    s_cselect_b32 s64, 0, s64
    s_waitcnt lgkmcnt(0)
    v_mfma_f32_16x16x32_bf16 v[72:75], v[8:11], v[24:27], 0
    ds_read_b128 v[56:59], v6 offset:8192
    v_mfma_f32_16x16x32_bf16 v[76:79], v[8:11], v[28:31], 0
    ds_read_b128 v[60:63], v6 offset:8448
    v_mfma_f32_16x16x32_bf16 v[80:83], v[8:11], v[32:35], 0
    ds_read_b128 v[64:67], v6 offset:8704
    v_mfma_f32_16x16x32_bf16 v[84:87], v[8:11], v[36:39], 0
    ds_read_b128 v[68:71], v6 offset:8960
    v_mfma_f32_16x16x32_bf16 v[88:91], v[12:15], v[24:27], 0
    ds_read_b64_tr_b16 v[40:41], v2 offset:8192
    v_mfma_f32_16x16x32_bf16 v[92:95], v[12:15], v[28:31], 0
    ds_read_b64_tr_b16 v[42:43], v2 offset:9216
    v_mfma_f32_16x16x32_bf16 v[96:99], v[12:15], v[32:35], 0
    ds_read_b64_tr_b16 v[44:45], v3 offset:8192
    v_mfma_f32_16x16x32_bf16 v[100:103], v[12:15], v[36:39], 0
    ds_read_b64_tr_b16 v[46:47], v3 offset:9216
    v_mfma_f32_16x16x32_bf16 v[104:107], v[16:19], v[24:27], 0
    ds_read_b64_tr_b16 v[48:49], v4 offset:8192
    v_mfma_f32_16x16x32_bf16 v[108:111], v[16:19], v[28:31], 0
    ds_read_b64_tr_b16 v[50:51], v4 offset:9216
    v_mfma_f32_16x16x32_bf16 v[112:115], v[16:19], v[32:35], 0
    ds_read_b64_tr_b16 v[52:53], v5 offset:8192
    v_mfma_f32_16x16x32_bf16 v[116:119], v[16:19], v[36:39], 0
    ds_read_b64_tr_b16 v[54:55], v5 offset:9216
    v_mfma_f32_16x16x32_bf16 v[120:123], v[20:23], v[24:27], 0
    v_add_u32 v2, s65, v2
    v_mfma_f32_16x16x32_bf16 v[124:127], v[20:23], v[28:31], 0
    v_add_u32 v3, s65, v3
    v_mfma_f32_16x16x32_bf16 v[128:131], v[20:23], v[32:35], 0
    v_add_u32 v4, s65, v4
    v_mfma_f32_16x16x32_bf16 v[132:135], v[20:23], v[36:39], 0
    v_add_u32 v5, s65, v5
    v_add_u32 v6, s65, v6
    s_waitcnt vmcnt(0) lgkmcnt(0)
    s_barrier
    s_mov_b32 s67, 0
L_g2c_73:
    v_mfma_f32_16x16x32_bf16 v[72:75], v[40:43], v[56:59], v[72:75]
    ds_read_b128 v[24:27], v6 offset:0
    v_mfma_f32_16x16x32_bf16 v[76:79], v[40:43], v[60:63], v[76:79]
    ds_read_b128 v[28:31], v6 offset:256
    v_mfma_f32_16x16x32_bf16 v[80:83], v[40:43], v[64:67], v[80:83]
    ds_read_b128 v[32:35], v6 offset:512
    v_mfma_f32_16x16x32_bf16 v[84:87], v[40:43], v[68:71], v[84:87]
    ds_read_b128 v[36:39], v6 offset:768
    v_mfma_f32_16x16x32_bf16 v[88:91], v[44:47], v[56:59], v[88:91]
    ds_read_b64_tr_b16 v[8:9], v2 offset:0
    v_mfma_f32_16x16x32_bf16 v[92:95], v[44:47], v[60:63], v[92:95]
    ds_read_b64_tr_b16 v[10:11], v2 offset:1024
    v_mfma_f32_16x16x32_bf16 v[96:99], v[44:47], v[64:67], v[96:99]
    ds_read_b64_tr_b16 v[12:13], v3 offset:0
    v_mfma_f32_16x16x32_bf16 v[100:103], v[44:47], v[68:71], v[100:103]
    ds_read_b64_tr_b16 v[14:15], v3 offset:1024
    v_mfma_f32_16x16x32_bf16 v[104:107], v[48:51], v[56:59], v[104:107]
    ds_read_b64_tr_b16 v[16:17], v4 offset:0
    v_mfma_f32_16x16x32_bf16 v[108:111], v[48:51], v[60:63], v[108:111]
    ds_read_b64_tr_b16 v[18:19], v4 offset:1024
    v_mfma_f32_16x16x32_bf16 v[112:115], v[48:51], v[64:67], v[112:115]
    ds_read_b64_tr_b16 v[20:21], v5 offset:0
    v_mfma_f32_16x16x32_bf16 v[116:119], v[48:51], v[68:71], v[116:119]
    ds_read_b64_tr_b16 v[22:23], v5 offset:1024
    v_mfma_f32_16x16x32_bf16 v[120:123], v[52:55], v[56:59], v[120:123]
    s_add_u32 s64, s64, 1
    v_mfma_f32_16x16x32_bf16 v[124:127], v[52:55], v[60:63], v[124:127]
    s_cmp_eq_u32 s64, 5
    v_mfma_f32_16x16x32_bf16 v[128:131], v[52:55], v[64:67], v[128:131]
    s_cselect_b32 s65, s63, s62
    v_mfma_f32_16x16x32_bf16 v[132:135], v[52:55], v[68:71], v[132:135]
    s_cselect_b32 s64, 0, s64
    s_waitcnt lgkmcnt(6)
    v_mfma_f32_16x16x32_bf16 v[72:75], v[8:11], v[24:27], v[72:75]
    ds_read_b128 v[56:59], v6 offset:8192
    v_mfma_f32_16x16x32_bf16 v[76:79], v[8:11], v[28:31], v[76:79]
    ds_read_b128 v[60:63], v6 offset:8448
    v_mfma_f32_16x16x32_bf16 v[80:83], v[8:11], v[32:35], v[80:83]
    ds_read_b128 v[64:67], v6 offset:8704
    v_mfma_f32_16x16x32_bf16 v[84:87], v[8:11], v[36:39], v[84:87]
    ds_read_b128 v[68:71], v6 offset:8960
    s_waitcnt lgkmcnt(8)
    v_mfma_f32_16x16x32_bf16 v[88:91], v[12:15], v[24:27], v[88:91]
    ds_read_b64_tr_b16 v[40:41], v2 offset:8192
    v_mfma_f32_16x16x32_bf16 v[92:95], v[12:15], v[28:31], v[92:95]
    ds_read_b64_tr_b16 v[42:43], v2 offset:9216
    v_mfma_f32_16x16x32_bf16 v[96:99], v[12:15], v[32:35], v[96:99]
    ds_read_b64_tr_b16 v[44:45], v3 offset:8192
    v_mfma_f32_16x16x32_bf16 v[100:103], v[12:15], v[36:39], v[100:103]
    ds_read_b64_tr_b16 v[46:47], v3 offset:9216
    s_waitcnt lgkmcnt(10)
    v_mfma_f32_16x16x32_bf16 v[104:107], v[16:19], v[24:27], v[104:107]
    ds_read_b64_tr_b16 v[48:49], v4 offset:8192
    v_mfma_f32_16x16x32_bf16 v[108:111], v[16:19], v[28:31], v[108:111]
    ds_read_b64_tr_b16 v[50:51], v4 offset:9216
    v_mfma_f32_16x16x32_bf16 v[112:115], v[16:19], v[32:35], v[112:115]
    ds_read_b64_tr_b16 v[52:53], v5 offset:8192
    v_mfma_f32_16x16x32_bf16 v[116:119], v[16:19], v[36:39], v[116:119]
    ds_read_b64_tr_b16 v[54:55], v5 offset:9216
    s_waitcnt lgkmcnt(12)
    v_mfma_f32_16x16x32_bf16 v[120:123], v[20:23], v[24:27], v[120:123]
    v_add_u32 v2, s65, v2
    v_mfma_f32_16x16x32_bf16 v[124:127], v[20:23], v[28:31], v[124:127]
    v_add_u32 v3, s65, v3
    v_mfma_f32_16x16x32_bf16 v[128:131], v[20:23], v[32:35], v[128:131]
    v_add_u32 v4, s65, v4
    v_mfma_f32_16x16x32_bf16 v[132:135], v[20:23], v[36:39], v[132:135]
    v_add_u32 v5, s65, v5
    v_add_u32 v6, s65, v6
    s_waitcnt lgkmcnt(0)
    s_barrier
    v_mfma_f32_16x16x32_bf16 v[72:75], v[40:43], v[56:59], v[72:75]
    ds_read_b128 v[24:27], v6 offset:0
    v_mfma_f32_16x16x32_bf16 v[76:79], v[40:43], v[60:63], v[76:79]
    ds_read_b128 v[28:31], v6 offset:256
    v_mfma_f32_16x16x32_bf16 v[80:83], v[40:43], v[64:67], v[80:83]
    ds_read_b128 v[32:35], v6 offset:512
    v_mfma_f32_16x16x32_bf16 v[84:87], v[40:43], v[68:71], v[84:87]
    ds_read_b128 v[36:39], v6 offset:768
    v_mfma_f32_16x16x32_bf16 v[88:91], v[44:47], v[56:59], v[88:91]
    ds_read_b64_tr_b16 v[8:9], v2 offset:0
    v_mfma_f32_16x16x32_bf16 v[92:95], v[44:47], v[60:63], v[92:95]
    ds_read_b64_tr_b16 v[10:11], v2 offset:1024
    v_mfma_f32_16x16x32_bf16 v[96:99], v[44:47], v[64:67], v[96:99]
    ds_read_b64_tr_b16 v[12:13], v3 offset:0
    v_mfma_f32_16x16x32_bf16 v[100:103], v[44:47], v[68:71], v[100:103]
    ds_read_b64_tr_b16 v[14:15], v3 offset:1024
    v_mfma_f32_16x16x32_bf16 v[104:107], v[48:51], v[56:59], v[104:107]
    ds_read_b64_tr_b16 v[16:17], v4 offset:0
    v_mfma_f32_16x16x32_bf16 v[108:111], v[48:51], v[60:63], v[108:111]
    ds_read_b64_tr_b16 v[18:19], v4 offset:1024
    v_mfma_f32_16x16x32_bf16 v[112:115], v[48:51], v[64:67], v[112:115]
    ds_read_b64_tr_b16 v[20:21], v5 offset:0
    v_mfma_f32_16x16x32_bf16 v[116:119], v[48:51], v[68:71], v[116:119]
    ds_read_b64_tr_b16 v[22:23], v5 offset:1024
    v_mfma_f32_16x16x32_bf16 v[120:123], v[52:55], v[56:59], v[120:123]
    s_add_u32 s64, s64, 1
    v_mfma_f32_16x16x32_bf16 v[124:127], v[52:55], v[60:63], v[124:127]
    s_cmp_eq_u32 s64, 5
    v_mfma_f32_16x16x32_bf16 v[128:131], v[52:55], v[64:67], v[128:131]
    s_cselect_b32 s65, s63, s62
    v_mfma_f32_16x16x32_bf16 v[132:135], v[52:55], v[68:71], v[132:135]
    s_cselect_b32 s64, 0, s64
    s_waitcnt lgkmcnt(6)
    v_mfma_f32_16x16x32_bf16 v[72:75], v[8:11], v[24:27], v[72:75]
    ds_read_b128 v[56:59], v6 offset:8192
    v_mfma_f32_16x16x32_bf16 v[76:79], v[8:11], v[28:31], v[76:79]
    ds_read_b128 v[60:63], v6 offset:8448
    v_mfma_f32_16x16x32_bf16 v[80:83], v[8:11], v[32:35], v[80:83]
    ds_read_b128 v[64:67], v6 offset:8704
    v_mfma_f32_16x16x32_bf16 v[84:87], v[8:11], v[36:39], v[84:87]
    ds_read_b128 v[68:71], v6 offset:8960
    s_waitcnt lgkmcnt(8)
    v_mfma_f32_16x16x32_bf16 v[88:91], v[12:15], v[24:27], v[88:91]
    ds_read_b64_tr_b16 v[40:41], v2 offset:8192
    v_mfma_f32_16x16x32_bf16 v[92:95], v[12:15], v[28:31], v[92:95]
    ds_read_b64_tr_b16 v[42:43], v2 offset:9216
    v_mfma_f32_16x16x32_bf16 v[96:99], v[12:15], v[32:35], v[96:99]
    ds_read_b64_tr_b16 v[44:45], v3 offset:8192
    v_mfma_f32_16x16x32_bf16 v[100:103], v[12:15], v[36:39], v[100:103]
    ds_read_b64_tr_b16 v[46:47], v3 offset:9216
    s_waitcnt lgkmcnt(10)
    v_mfma_f32_16x16x32_bf16 v[104:107], v[16:19], v[24:27], v[104:107]
    ds_read_b64_tr_b16 v[48:49], v4 offset:8192
    v_mfma_f32_16x16x32_bf16 v[108:111], v[16:19], v[28:31], v[108:111]
    ds_read_b64_tr_b16 v[50:51], v4 offset:9216
    v_mfma_f32_16x16x32_bf16 v[112:115], v[16:19], v[32:35], v[112:115]
    ds_read_b64_tr_b16 v[52:53], v5 offset:8192
    v_mfma_f32_16x16x32_bf16 v[116:119], v[16:19], v[36:39], v[116:119]
    ds_read_b64_tr_b16 v[54:55], v5 offset:9216
    s_waitcnt lgkmcnt(12)
    v_mfma_f32_16x16x32_bf16 v[120:123], v[20:23], v[24:27], v[120:123]
    v_add_u32 v2, s65, v2
    v_mfma_f32_16x16x32_bf16 v[124:127], v[20:23], v[28:31], v[124:127]
    v_add_u32 v3, s65, v3
    v_mfma_f32_16x16x32_bf16 v[128:131], v[20:23], v[32:35], v[128:131]
    v_add_u32 v4, s65, v4
    v_mfma_f32_16x16x32_bf16 v[132:135], v[20:23], v[36:39], v[132:135]
    v_add_u32 v5, s65, v5
    v_add_u32 v6, s65, v6
    s_waitcnt lgkmcnt(0)
    s_barrier
    v_mfma_f32_16x16x32_bf16 v[72:75], v[40:43], v[56:59], v[72:75]
    ds_read_b128 v[24:27], v6 offset:0
    v_mfma_f32_16x16x32_bf16 v[76:79], v[40:43], v[60:63], v[76:79]
    ds_read_b128 v[28:31], v6 offset:256
    v_mfma_f32_16x16x32_bf16 v[80:83], v[40:43], v[64:67], v[80:83]
    ds_read_b128 v[32:35], v6 offset:512
    v_mfma_f32_16x16x32_bf16 v[84:87], v[40:43], v[68:71], v[84:87]
    ds_read_b128 v[36:39], v6 offset:768
    v_mfma_f32_16x16x32_bf16 v[88:91], v[44:47], v[56:59], v[88:91]
    ds_read_b64_tr_b16 v[8:9], v2 offset:0
    v_mfma_f32_16x16x32_bf16 v[92:95], v[44:47], v[60:63], v[92:95]
    ds_read_b64_tr_b16 v[10:11], v2 offset:1024
    v_mfma_f32_16x16x32_bf16 v[96:99], v[44:47], v[64:67], v[96:99]
    ds_read_b64_tr_b16 v[12:13], v3 offset:0
    v_mfma_f32_16x16x32_bf16 v[100:103], v[44:47], v[68:71], v[100:103]
    ds_read_b64_tr_b16 v[14:15], v3 offset:1024
    v_mfma_f32_16x16x32_bf16 v[104:107], v[48:51], v[56:59], v[104:107]
    ds_read_b64_tr_b16 v[16:17], v4 offset:0
    v_mfma_f32_16x16x32_bf16 v[108:111], v[48:51], v[60:63], v[108:111]
    ds_read_b64_tr_b16 v[18:19], v4 offset:1024
    v_mfma_f32_16x16x32_bf16 v[112:115], v[48:51], v[64:67], v[112:115]
    ds_read_b64_tr_b16 v[20:21], v5 offset:0
    v_mfma_f32_16x16x32_bf16 v[116:119], v[48:51], v[68:71], v[116:119]
    ds_read_b64_tr_b16 v[22:23], v5 offset:1024
    v_mfma_f32_16x16x32_bf16 v[120:123], v[52:55], v[56:59], v[120:123]
    s_add_u32 s64, s64, 1
    v_mfma_f32_16x16x32_bf16 v[124:127], v[52:55], v[60:63], v[124:127]
    s_cmp_eq_u32 s64, 5
    v_mfma_f32_16x16x32_bf16 v[128:131], v[52:55], v[64:67], v[128:131]
    s_cselect_b32 s65, s63, s62
    v_mfma_f32_16x16x32_bf16 v[132:135], v[52:55], v[68:71], v[132:135]
    s_cselect_b32 s64, 0, s64
    s_waitcnt lgkmcnt(6)
    v_mfma_f32_16x16x32_bf16 v[72:75], v[8:11], v[24:27], v[72:75]
    ds_read_b128 v[56:59], v6 offset:8192
    v_mfma_f32_16x16x32_bf16 v[76:79], v[8:11], v[28:31], v[76:79]
    ds_read_b128 v[60:63], v6 offset:8448
    v_mfma_f32_16x16x32_bf16 v[80:83], v[8:11], v[32:35], v[80:83]
    ds_read_b128 v[64:67], v6 offset:8704
    v_mfma_f32_16x16x32_bf16 v[84:87], v[8:11], v[36:39], v[84:87]
    ds_read_b128 v[68:71], v6 offset:8960
    s_waitcnt lgkmcnt(8)
    v_mfma_f32_16x16x32_bf16 v[88:91], v[12:15], v[24:27], v[88:91]
    ds_read_b64_tr_b16 v[40:41], v2 offset:8192
    v_mfma_f32_16x16x32_bf16 v[92:95], v[12:15], v[28:31], v[92:95]
    ds_read_b64_tr_b16 v[42:43], v2 offset:9216
    v_mfma_f32_16x16x32_bf16 v[96:99], v[12:15], v[32:35], v[96:99]
    ds_read_b64_tr_b16 v[44:45], v3 offset:8192
    v_mfma_f32_16x16x32_bf16 v[100:103], v[12:15], v[36:39], v[100:103]
    ds_read_b64_tr_b16 v[46:47], v3 offset:9216
    s_waitcnt lgkmcnt(10)
    v_mfma_f32_16x16x32_bf16 v[104:107], v[16:19], v[24:27], v[104:107]
    ds_read_b64_tr_b16 v[48:49], v4 offset:8192
    v_mfma_f32_16x16x32_bf16 v[108:111], v[16:19], v[28:31], v[108:111]
    ds_read_b64_tr_b16 v[50:51], v4 offset:9216
    v_mfma_f32_16x16x32_bf16 v[112:115], v[16:19], v[32:35], v[112:115]
    ds_read_b64_tr_b16 v[52:53], v5 offset:8192
    v_mfma_f32_16x16x32_bf16 v[116:119], v[16:19], v[36:39], v[116:119]
    ds_read_b64_tr_b16 v[54:55], v5 offset:9216
    s_waitcnt lgkmcnt(12)
    v_mfma_f32_16x16x32_bf16 v[120:123], v[20:23], v[24:27], v[120:123]
    v_add_u32 v2, s65, v2
    v_mfma_f32_16x16x32_bf16 v[124:127], v[20:23], v[28:31], v[124:127]
    v_add_u32 v3, s65, v3
    v_mfma_f32_16x16x32_bf16 v[128:131], v[20:23], v[32:35], v[128:131]
    v_add_u32 v4, s65, v4
    v_mfma_f32_16x16x32_bf16 v[132:135], v[20:23], v[36:39], v[132:135]
    v_add_u32 v5, s65, v5
    v_add_u32 v6, s65, v6
    s_add_u32 s67, s67, 1
    s_cmp_lt_u32 s67, 9
    s_waitcnt lgkmcnt(0)
    s_barrier
    s_cbranch_scc1 L_g2c_73
    v_mfma_f32_16x16x32_bf16 v[72:75], v[40:43], v[56:59], v[72:75]
    v_mfma_f32_16x16x32_bf16 v[76:79], v[40:43], v[60:63], v[76:79]
    v_mfma_f32_16x16x32_bf16 v[80:83], v[40:43], v[64:67], v[80:83]
    v_mfma_f32_16x16x32_bf16 v[84:87], v[40:43], v[68:71], v[84:87]
    v_mfma_f32_16x16x32_bf16 v[88:91], v[44:47], v[56:59], v[88:91]
    v_mfma_f32_16x16x32_bf16 v[92:95], v[44:47], v[60:63], v[92:95]
    v_mfma_f32_16x16x32_bf16 v[96:99], v[44:47], v[64:67], v[96:99]
    v_mfma_f32_16x16x32_bf16 v[100:103], v[44:47], v[68:71], v[100:103]
    v_mfma_f32_16x16x32_bf16 v[104:107], v[48:51], v[56:59], v[104:107]
    v_mfma_f32_16x16x32_bf16 v[108:111], v[48:51], v[60:63], v[108:111]
    v_mfma_f32_16x16x32_bf16 v[112:115], v[48:51], v[64:67], v[112:115]
    v_mfma_f32_16x16x32_bf16 v[116:119], v[48:51], v[68:71], v[116:119]
    v_mfma_f32_16x16x32_bf16 v[120:123], v[52:55], v[56:59], v[120:123]
    v_mfma_f32_16x16x32_bf16 v[124:127], v[52:55], v[60:63], v[124:127]
    v_mfma_f32_16x16x32_bf16 v[128:131], v[52:55], v[64:67], v[128:131]
    v_mfma_f32_16x16x32_bf16 v[132:135], v[52:55], v[68:71], v[132:135]
    s_cmp_eq_u32 s69, 0
    s_cbranch_scc1 L_g2k_74
    v_swap_b32 v72, v80
    v_swap_b32 v73, v81
    v_swap_b32 v74, v82
    v_swap_b32 v75, v83
    v_swap_b32 v76, v84
    v_swap_b32 v77, v85
    v_swap_b32 v78, v86
    v_swap_b32 v79, v87
    v_swap_b32 v88, v96
    v_swap_b32 v89, v97
    v_swap_b32 v90, v98
    v_swap_b32 v91, v99
    v_swap_b32 v92, v100
    v_swap_b32 v93, v101
    v_swap_b32 v94, v102
    v_swap_b32 v95, v103
    v_swap_b32 v104, v112
    v_swap_b32 v105, v113
    v_swap_b32 v106, v114
    v_swap_b32 v107, v115
    v_swap_b32 v108, v116
    v_swap_b32 v109, v117
    v_swap_b32 v110, v118
    v_swap_b32 v111, v119
    v_swap_b32 v120, v128
    v_swap_b32 v121, v129
    v_swap_b32 v122, v130
    v_swap_b32 v123, v131
    v_swap_b32 v124, v132
    v_swap_b32 v125, v133
    v_swap_b32 v126, v134
    v_swap_b32 v127, v135
L_g2k_74:
    s_xor_b32 s56, s2, 4
    s_lshl_b32 s56, s56, 15
    s_lshl_b32 s57, s52, 13
    s_add_u32 s56, s56, s57
    s_add_u32 s62, s56, 29360128
    v_lshlrev_b32 v8, 4, v0
    s_add_u32 s56, s62, 0
    buffer_store_dwordx4 v[80:83], v8, s[36:39], s56 offen sc1
    s_add_u32 s56, s62, 1024
    buffer_store_dwordx4 v[84:87], v8, s[36:39], s56 offen sc1
    s_add_u32 s56, s62, 2048
    buffer_store_dwordx4 v[96:99], v8, s[36:39], s56 offen sc1
    s_add_u32 s56, s62, 3072
    buffer_store_dwordx4 v[100:103], v8, s[36:39], s56 offen sc1
    s_add_u32 s56, s62, 4096
    buffer_store_dwordx4 v[112:115], v8, s[36:39], s56 offen sc1
    s_add_u32 s56, s62, 5120
    buffer_store_dwordx4 v[116:119], v8, s[36:39], s56 offen sc1
    s_add_u32 s56, s62, 6144
    buffer_store_dwordx4 v[128:131], v8, s[36:39], s56 offen sc1
    s_add_u32 s56, s62, 7168
    buffer_store_dwordx4 v[132:135], v8, s[36:39], s56 offen sc1
    v_lshrrev_b32 v13, 4, v0
    v_and_b32 v14, 15, v0
    v_lshrrev_b32 v15, 2, v14
    v_and_b32 v16, 3, v14
    v_lshl_add_u32 v17, v13, 2, v15
    v_lshlrev_b32 v17, 6, v17
    v_lshl_add_u32 v17, v16, 3, v17
    s_lshl_b32 s56, s59, 13
    s_lshl_b32 s57, s58, 12
    s_add_u32 s56, s56, s57
    s_add_u32 s56, s56, 98304
    v_add_u32 v17, s56, v17
    ds_read_b64_tr_b16 v[168:169], v17 offset:0
    ds_read_b64_tr_b16 v[170:171], v17 offset:32
    ds_read_b64_tr_b16 v[172:173], v17 offset:1024
    ds_read_b64_tr_b16 v[174:175], v17 offset:1056
    ds_read_b64_tr_b16 v[176:177], v17 offset:2048
    ds_read_b64_tr_b16 v[178:179], v17 offset:2080
    ds_read_b64_tr_b16 v[180:181], v17 offset:3072
    ds_read_b64_tr_b16 v[182:183], v17 offset:3104
    s_lshl_b32 s56, s2, 15
    s_lshl_b32 s57, s52, 13
    s_add_u32 s56, s56, s57
    s_add_u32 s62, s56, 29360128
    s_add_u32 s81, s62, 1024
    s_add_u32 s82, s62, 2048
    s_add_u32 s83, s62, 3072
    s_add_u32 s84, s62, 4096
    s_add_u32 s85, s62, 5120
    s_add_u32 s86, s62, 6144
    s_add_u32 s87, s62, 7168
    s_mov_b32 s80, s62
    s_mov_b32 s40, s30
    s_mov_b32 s41, s31
    s_mov_b32 s42, 4194304
    s_mov_b32 s43, 0x20000
    s_lshl_b32 s56, s52, 12
    v_and_b32 v10, 1, v13
    v_lshlrev_b32 v10, 1, v10
    v_lshrrev_b32 v11, 1, v13
    v_add_u32 v10, v10, v11
    v_and_b32 v11, 7, v14
    v_add_u32 v12, 0, v10
    v_xor_b32 v12, v12, v11
    v_lshlrev_b32 v12, 4, v12
    v_lshl_add_u32 v12, v14, 7, v12
    v_add_u32 v32, s56, v12
    v_add_u32 v12, 4, v10
    v_xor_b32 v12, v12, v11
    v_lshlrev_b32 v12, 4, v12
    v_lshl_add_u32 v12, v14, 7, v12
    v_add_u32 v33, s56, v12
    v_lshrrev_b32 v11, 3, v0
    v_and_b32 v12, 7, v0
    v_xor_b32 v10, v12, v11
    v_lshlrev_b32 v10, 4, v10
    v_lshl_add_u32 v10, v11, 7, v10
    v_add_u32 v34, s56, v10
    s_lshl_b32 s56, s60, 7
    s_lshl_b32 s57, s59, 6
    s_add_u32 s56, s56, s57
    s_lshl_b32 s57, s69, 5
    s_add_u32 s56, s56, s57
    v_add_u32 v9, s56, v11
    v_lshlrev_b32 v9, 11, v9
    v_lshl_add_u32 v9, v12, 4, v9
    s_mov_b32 s56, s61
    s_lshl_b32 s56, s56, 8
    s_lshl_b32 s57, s58, 7
    s_add_u32 s63, s56, s57
    v_lshlrev_b32 v40, 16, v234
    v_and_b32 v41, 0xffff0000, v234
    v_lshlrev_b32 v42, 16, v235
    v_and_b32 v43, 0xffff0000, v235
    v_lshlrev_b32 v44, 16, v236
    v_and_b32 v45, 0xffff0000, v236
    v_lshlrev_b32 v46, 16, v237
    v_and_b32 v47, 0xffff0000, v237
    v_lshlrev_b32 v48, 16, v238
    v_and_b32 v49, 0xffff0000, v238
    v_lshlrev_b32 v50, 16, v239
    v_and_b32 v51, 0xffff0000, v239
    v_lshlrev_b32 v52, 16, v240
    v_and_b32 v53, 0xffff0000, v240
    v_lshlrev_b32 v54, 16, v241
    v_and_b32 v55, 0xffff0000, v241
    s_mov_b32 s57, 0x200000
    s_mov_b32 exec_lo, 0
    s_mov_b32 exec_hi, 0x80000000
L_g2w1_77:
    buffer_load_dword v35, v8, s[36:39], s87 offen offset:12 sc1
    s_sub_u32 s57, s57, 1
    s_cmp_eq_u32 s57, 0
    s_cbranch_scc1 L_g2w1x_78
    s_waitcnt vmcnt(0)
    v_cmp_eq_u32 vcc, -1, v35
    s_cbranch_vccnz L_g2w1_77
L_g2w1x_78:
    s_waitcnt vmcnt(0)
    s_mov_b64 exec, -1
    s_mov_b32 s57, 0x200000
L_g2in_75:
    buffer_load_dwordx4 v[136:139], v8, s[36:39], s80 offen sc1
    buffer_load_dwordx4 v[140:143], v8, s[36:39], s81 offen sc1
    buffer_load_dwordx4 v[144:147], v8, s[36:39], s82 offen sc1
    buffer_load_dwordx4 v[148:151], v8, s[36:39], s83 offen sc1
    buffer_load_dwordx4 v[152:155], v8, s[36:39], s84 offen sc1
    buffer_load_dwordx4 v[156:159], v8, s[36:39], s85 offen sc1
    buffer_load_dwordx4 v[160:163], v8, s[36:39], s86 offen sc1
    buffer_load_dwordx4 v[164:167], v8, s[36:39], s87 offen sc1
    s_sub_u32 s57, s57, 1
    s_cmp_eq_u32 s57, 0
    s_cbranch_scc1 L_g2inx_76
    s_waitcnt vmcnt(0)
    v_max_u32 v35, v136, v139
    v_max3_u32 v35, v35, v140, v143
    v_max3_u32 v35, v35, v144, v147
    v_max3_u32 v35, v35, v148, v151
    v_max3_u32 v35, v35, v152, v155
    v_max3_u32 v35, v35, v156, v159
    v_max3_u32 v35, v35, v160, v163
    v_max3_u32 v35, v35, v164, v167
    v_cmp_eq_u32 vcc, -1, v35
    s_cbranch_vccnz L_g2in_75
L_g2inx_76:
    s_waitcnt vmcnt(0) lgkmcnt(0)
    v_lshlrev_b32 v64, 16, v168
    v_and_b32 v65, 0xffff0000, v168
    v_lshlrev_b32 v66, 16, v169
    v_and_b32 v67, 0xffff0000, v169
    v_pk_add_f32 v[72:73], v[72:73], v[136:137]
    v_pk_add_f32 v[64:65], v[64:65], v[40:41]
    v_pk_add_f32 v[72:73], v[72:73], v[64:65]
    v_cvt_pk_bf16_f32 v56, v72, v73
    v_pk_add_f32 v[74:75], v[74:75], v[138:139]
    v_pk_add_f32 v[66:67], v[66:67], v[42:43]
    v_pk_add_f32 v[74:75], v[74:75], v[66:67]
    v_cvt_pk_bf16_f32 v57, v74, v75
    v_lshlrev_b32 v64, 16, v172
    v_and_b32 v65, 0xffff0000, v172
    v_lshlrev_b32 v66, 16, v173
    v_and_b32 v67, 0xffff0000, v173
    v_pk_add_f32 v[88:89], v[88:89], v[144:145]
    v_pk_add_f32 v[64:65], v[64:65], v[44:45]
    v_pk_add_f32 v[88:89], v[88:89], v[64:65]
    v_cvt_pk_bf16_f32 v58, v88, v89
    v_pk_add_f32 v[90:91], v[90:91], v[146:147]
    v_pk_add_f32 v[66:67], v[66:67], v[46:47]
    v_pk_add_f32 v[90:91], v[90:91], v[66:67]
    v_cvt_pk_bf16_f32 v59, v90, v91
    v_permlane16_swap_b32 v56, v58
    s_nop 0
    v_permlane16_swap_b32 v57, v59
    ds_write_b128 v32, v[56:59] offset:0
    v_lshlrev_b32 v64, 16, v176
    v_and_b32 v65, 0xffff0000, v176
    v_lshlrev_b32 v66, 16, v177
    v_and_b32 v67, 0xffff0000, v177
    v_pk_add_f32 v[104:105], v[104:105], v[152:153]
    v_pk_add_f32 v[64:65], v[64:65], v[48:49]
    v_pk_add_f32 v[104:105], v[104:105], v[64:65]
    v_cvt_pk_bf16_f32 v60, v104, v105
    v_pk_add_f32 v[106:107], v[106:107], v[154:155]
    v_pk_add_f32 v[66:67], v[66:67], v[50:51]
    v_pk_add_f32 v[106:107], v[106:107], v[66:67]
    v_cvt_pk_bf16_f32 v61, v106, v107
    v_lshlrev_b32 v64, 16, v180
    v_and_b32 v65, 0xffff0000, v180
    v_lshlrev_b32 v66, 16, v181
    v_and_b32 v67, 0xffff0000, v181
    v_pk_add_f32 v[120:121], v[120:121], v[160:161]
    v_pk_add_f32 v[64:65], v[64:65], v[52:53]
    v_pk_add_f32 v[120:121], v[120:121], v[64:65]
    v_cvt_pk_bf16_f32 v62, v120, v121
    v_pk_add_f32 v[122:123], v[122:123], v[162:163]
    v_pk_add_f32 v[66:67], v[66:67], v[54:55]
    v_pk_add_f32 v[122:123], v[122:123], v[66:67]
    v_cvt_pk_bf16_f32 v63, v122, v123
    v_permlane16_swap_b32 v60, v62
    s_nop 0
    v_permlane16_swap_b32 v61, v63
    ds_write_b128 v33, v[60:63] offset:0
    v_lshlrev_b32 v64, 16, v170
    v_and_b32 v65, 0xffff0000, v170
    v_lshlrev_b32 v66, 16, v171
    v_and_b32 v67, 0xffff0000, v171
    v_pk_add_f32 v[76:77], v[76:77], v[140:141]
    v_pk_add_f32 v[64:65], v[64:65], v[40:41]
    v_pk_add_f32 v[76:77], v[76:77], v[64:65]
    v_cvt_pk_bf16_f32 v56, v76, v77
    v_pk_add_f32 v[78:79], v[78:79], v[142:143]
    v_pk_add_f32 v[66:67], v[66:67], v[42:43]
    v_pk_add_f32 v[78:79], v[78:79], v[66:67]
    v_cvt_pk_bf16_f32 v57, v78, v79
    v_lshlrev_b32 v64, 16, v174
    v_and_b32 v65, 0xffff0000, v174
    v_lshlrev_b32 v66, 16, v175
    v_and_b32 v67, 0xffff0000, v175
    v_pk_add_f32 v[92:93], v[92:93], v[148:149]
    v_pk_add_f32 v[64:65], v[64:65], v[44:45]
    v_pk_add_f32 v[92:93], v[92:93], v[64:65]
    v_cvt_pk_bf16_f32 v58, v92, v93
    v_pk_add_f32 v[94:95], v[94:95], v[150:151]
    v_pk_add_f32 v[66:67], v[66:67], v[46:47]
    v_pk_add_f32 v[94:95], v[94:95], v[66:67]
    v_cvt_pk_bf16_f32 v59, v94, v95
    v_permlane16_swap_b32 v56, v58
    s_nop 0
    v_permlane16_swap_b32 v57, v59
    ds_write_b128 v32, v[56:59] offset:2048
    v_lshlrev_b32 v64, 16, v178
    v_and_b32 v65, 0xffff0000, v178
    v_lshlrev_b32 v66, 16, v179
    v_and_b32 v67, 0xffff0000, v179
    v_pk_add_f32 v[108:109], v[108:109], v[156:157]
    v_pk_add_f32 v[64:65], v[64:65], v[48:49]
    v_pk_add_f32 v[108:109], v[108:109], v[64:65]
    v_cvt_pk_bf16_f32 v60, v108, v109
    v_pk_add_f32 v[110:111], v[110:111], v[158:159]
    v_pk_add_f32 v[66:67], v[66:67], v[50:51]
    v_pk_add_f32 v[110:111], v[110:111], v[66:67]
    v_cvt_pk_bf16_f32 v61, v110, v111
    v_lshlrev_b32 v64, 16, v182
    v_and_b32 v65, 0xffff0000, v182
    v_lshlrev_b32 v66, 16, v183
    v_and_b32 v67, 0xffff0000, v183
    v_pk_add_f32 v[124:125], v[124:125], v[164:165]
    v_pk_add_f32 v[64:65], v[64:65], v[52:53]
    v_pk_add_f32 v[124:125], v[124:125], v[64:65]
    v_cvt_pk_bf16_f32 v62, v124, v125
    v_pk_add_f32 v[126:127], v[126:127], v[166:167]
    v_pk_add_f32 v[66:67], v[66:67], v[54:55]
    v_pk_add_f32 v[126:127], v[126:127], v[66:67]
    v_cvt_pk_bf16_f32 v63, v126, v127
    v_permlane16_swap_b32 v60, v62
    s_nop 0
    v_permlane16_swap_b32 v61, v63
    ds_write_b128 v33, v[60:63] offset:2048
    s_waitcnt lgkmcnt(0)
    ds_read_b128 v[72:75], v34 offset:0
    ds_read_b128 v[76:79], v34 offset:1024
    ds_read_b128 v[80:83], v34 offset:2048
    ds_read_b128 v[84:87], v34 offset:3072
    s_add_u32 s56, s63, 0
    s_waitcnt lgkmcnt(3)
    buffer_store_dwordx4 v[72:75], v9, s[40:43], s56 offen sc1 nt
    s_add_u32 s56, s63, 16384
    s_waitcnt lgkmcnt(2)
    buffer_store_dwordx4 v[76:79], v9, s[40:43], s56 offen sc1 nt
    s_add_u32 s56, s63, 32768
    s_waitcnt lgkmcnt(1)
    buffer_store_dwordx4 v[80:83], v9, s[40:43], s56 offen sc1 nt
    s_add_u32 s56, s63, 49152
    s_waitcnt lgkmcnt(0)
    buffer_store_dwordx4 v[84:87], v9, s[40:43], s56 offen sc1 nt
L_g2end_62:
L_end:
    s_endpgm

.section .rodata,"a"
.p2align 6
.amdhsa_kernel sequential_preLN__ssm_conv_h3__mixer_channel_mlp__prompt_kernel
  .amdhsa_next_free_vgpr 256
  .amdhsa_next_free_sgpr 102
  .amdhsa_accum_offset 256
  .amdhsa_group_segment_fixed_size 0
  .amdhsa_kernarg_size 112
  .amdhsa_user_sgpr_count 2
  .amdhsa_user_sgpr_kernarg_segment_ptr 1
  .amdhsa_system_sgpr_workgroup_id_x 1
  .amdhsa_float_denorm_mode_32 3
.end_amdhsa_kernel
```
